```python
import torch

def _softmax(x, axis=-1):
    return torch.softmax(x, dim=axis)
def _gelu(x):
    return torch.nn.functional.gelu(x, approximate="tanh")
def _silu(x):
    return torch.nn.functional.silu(x)
def _sigmoid(x):
    return torch.sigmoid(x)
def _layernorm(x, axis=-1, eps=1e-5):
    m = x.mean(dim=axis, keepdim=True)
    v = x.var(dim=axis, keepdim=True, unbiased=False)
    return (x - m) / torch.sqrt(v + eps)
def _scatter_add(tgt, idx, src, axis=0):
    return tgt.clone().index_add_(axis, idx, src)
def _segment_sum(src, seg, n):
    out = torch.zeros((n,) + src.shape[1:], dtype=src.dtype)
    return out.index_add_(0, seg, src)
def _pad(x, pw):
    flat = tuple(v for pair in reversed(pw) for v in pair)
    return torch.nn.functional.pad(x, flat)

kernel_name = 'interleave_layers__linear_attn_block__softmax_full_mha__prompt'

def setup_inputs():

    _w = (lambda a: (lambda t: t.to(torch.bfloat16) if t.is_floating_point() else t)(torch.as_tensor(a)))
    def _A_setup():
        B, S, D = 1, 2048, 448
        return {
            "x": _w((lambda *s: torch.randn(*s, dtype=torch.bfloat16) * 0.05)(B, S, D)),
            "wqkv": _w((lambda *s: torch.randn(*s, dtype=torch.bfloat16) * 0.1)(D, 3 * D)),
            "wo": _w((lambda *s: torch.randn(*s, dtype=torch.bfloat16) * 0.05)(D, D)),
        }
    _A_in = _A_setup()

    def _B_setup():
        B, S, D = 1, 2048, 448
        return {
            "x": _w((lambda *s: torch.randn(*s, dtype=torch.bfloat16) * 0.05)(B, S, D)),
            "wqkv": _w((lambda *s: torch.randn(*s, dtype=torch.bfloat16) * 0.1)(D, 3 * D)),
            "wo": _w((lambda *s: torch.randn(*s, dtype=torch.bfloat16) * 0.05)(D, D)),
        }
    _B_in = _B_setup()

    return {
        "A_x": _A_in["x"],
        "A_wqkv": _A_in["wqkv"],
        "A_wo": _A_in["wo"],
        "B_x": _B_in["x"],
        "B_wqkv": _B_in["wqkv"],
        "B_wo": _B_in["wo"],
    }

def reference(A_x, A_wqkv, A_wo, B_x, B_wqkv, B_wo):
    def _A_ref(x, wqkv, wo):
        B, S, D = x.shape
        H = 16; Dh = D // H
        qkv = (lambda x, *d: x.permute(*d))((x @ wqkv).reshape(B, S, 3, H, Dh), 2, 0, 3, 1, 4)
        q, k, v = qkv[0], qkv[1], qkv[2]
        phi = lambda t: torch.where(t > 0, t + 1, torch.exp(t)) + 1e-6
        pq, pk = phi(q), phi(k)
        kv = torch.einsum("bhsd,bhse->bhde", pk, v)
        z = torch.einsum("bhsd->bhd", pk)
        num = torch.einsum("bhqd,bhde->bhqe", pq, kv)
        den = torch.einsum("bhqd,bhd->bhq", pq, z)[..., None] + 1e-6
        o = num / den
        return (lambda x, *d: x.permute(*d))(o, 0, 2, 1, 3).reshape(B, S, D) @ wo

    def _B_ref(x, wqkv, wo):
        B, S, D = x.shape
        H = 16; Dh = D // H
        qkv = (lambda x, *d: x.permute(*d))((x @ wqkv).reshape(B, S, 3, H, Dh), 2, 0, 3, 1, 4)
        q, k, v = qkv[0], qkv[1], qkv[2]
        scale = Dh ** -0.5
        scores = torch.einsum("bhqd,bhkd->bhqk", q, k) * scale
        p = _softmax(scores, axis=-1)
        o = torch.einsum("bhqk,bhkd->bhqd", p, v)
        return (lambda x, *d: x.permute(*d))(o, 0, 2, 1, 3).reshape(B, S, D) @ wo

    x = A_x
    x = x + _A_ref(_layernorm(x, axis=-1), A_wqkv, A_wo)
    x = x + _B_ref(_layernorm(x, axis=-1), B_wqkv, B_wo)
    x = x + _A_ref(_layernorm(x, axis=-1), A_wqkv, A_wo)
    x = x + _B_ref(_layernorm(x, axis=-1), B_wqkv, B_wo)
    return x
```

```asm
; @launch grid=(256,1,1) block=(256,1,1) lds=163840
.amdgcn_target "amdgcn-amd-amdhsa--gfx950"
.text
.globl interleave_layers__linear_attn_block__softmax_full_mha__prompt_kernel
.p2align 8
.type interleave_layers__linear_attn_block__softmax_full_mha__prompt_kernel,@function
interleave_layers__linear_attn_block__softmax_full_mha__prompt_kernel:
  s_cmp_ge_u32 s2, 256
  s_cbranch_scc1 k_end
  s_load_dwordx2 s[64:65], s[0:1], 0
  s_load_dwordx2 s[68:69], s[0:1], 8
  s_load_dwordx2 s[8:9], s[0:1], 64
  s_load_dwordx2 s[76:77], s[0:1], 16
  s_load_dwordx2 s[72:73], s[0:1], 32
  s_load_dwordx2 s[80:81], s[0:1], 40
  s_load_dwordx2 s[32:33], s[0:1], 48
  s_load_dwordx2 s[36:37], s[0:1], 56
  s_getpc_b64 s[54:55]
pc_base:
  s_sub_u32 s48, s2, 0
  s_cmp_ge_u32 s48, 16
  s_cbranch_scc1 ct_1
  s_lshr_b32 s48, s48, 3
  s_lshl_b32 s48, s48, 14
  v_lshl_add_u32 v254, v0, 6, s48
  v_min_u32 v254, code_end-pc_base-4, v254
  global_load_dword v255, v254, s[54:55]
ct_1:
  v_and_b32 v13, 63, v0
  v_lshrrev_b32 v4, 6, v0
  v_and_b32 v2, 31, v0
  v_readfirstlane_b32 s4, v4
  v_bfe_u32 v3, v0, 5, 1
  v_lshlrev_b32 v1, 4, v13
  v_mov_b32 v7, 0
  s_and_b32 s5, s2, 7
  s_lshr_b32 s6, s2, 3
  s_lshl_b32 s7, s5, 1
  s_and_b32 s12, s6, 1
  s_add_u32 s40, s7, s12
  s_lshr_b32 s41, s6, 1
  s_mov_b32 s67, 0x20000
  s_mov_b32 s71, 0x20000
  s_mov_b32 s66, 1835008
  s_mov_b32 s70, 1204224
  s_lshl_b32 s7, s40, 2
  s_add_u32 s7, s7, s4
  s_mul_i32 s20, s7, 28672
  v_lshrrev_b32 v174, 6, v1
  v_mul_u32_u24 v174, 2688, v174
  v_and_b32 v216, 48, v1
  s_mul_i32 s12, s41, 56
  s_and_b32 s14, s12, 8
  s_sub_u32 s12, s12, s14
  v_add3_u32 v174, v174, v216, s12
  s_lshl_b32 s23, s40, 1
  s_add_u32 s23, s23, s41
  s_mul_i32 s24, s23, 37
  s_lshr_b32 s24, s24, 8
  s_mul_i32 s24, s24, 7
  s_sub_u32 s23, s23, s24
  s_mul_i32 s15, s4, 3072
  s_mul_i32 s22, s4, 43008
  v_lshrrev_b32 v218, 7, v1
  v_mul_u32_u24 v218, 896, v218
  v_bfe_u32 v219, v1, 4, 3
  v_lshrrev_b32 v220, 8, v1
  v_xor_b32 v219, v219, v220
  v_lshl_add_u32 v164, v219, 4, v218
  v_xor_b32 v219, 4, v219
  v_lshl_add_u32 v165, v219, 4, v218
  s_mul_i32 s21, s4, 12288
  s_add_u32 s21, s21, 86016
  s_waitcnt lgkmcnt(0)
  s_and_b32 s65, s65, 0xffff
  s_and_b32 s69, s69, 0xffff
  s_mul_i32 s24, s23, 172032
  s_add_u32 s24, s24, s22
  s_add_u32 m0, s15, 1024
  s_add_u32 s24, s24, 896
  buffer_load_dwordx4 v174, s[68:71], s24 offen lds
  s_add_u32 m0, s15, 2048
  s_add_u32 s24, s24, 896
  buffer_load_dwordx4 v174, s[68:71], s24 offen lds
  s_add_u32 m0, s21, 0
  s_lshl_b32 s24, s23, 7
  s_add_u32 s24, s24, s20
  buffer_load_dwordx4 v164, s[64:67], s24 offen offset:0 lds
  s_add_u32 s24, s24, 6144
  buffer_load_dwordx4 v165, s[64:67], s24 offen offset:1024 lds
  s_add_u32 s24, s24, 6144
  buffer_load_dwordx4 v164, s[64:67], s24 offen offset:2048 lds
  s_add_u32 s24, s24, 6144
  buffer_load_dwordx4 v165, s[64:67], s24 offen offset:3072 lds
  s_add_u32 s23, s23, 1
  s_cmp_eq_u32 s23, 7
  s_cselect_b32 s23, 0, s23
  s_lshl_b32 s24, s5, 2
  s_and_b32 s25, s6, 3
  s_add_u32 s42, s24, s25
  s_lshr_b32 s43, s6, 2
  s_lshr_b32 s24, s4, 1
  s_lshl_b32 s25, s42, 1
  s_add_u32 s24, s24, s25
  s_and_b32 s25, s4, 1
  s_min_u32 s26, s43, 6
  s_lshl_b32 s26, s26, 1
  s_add_u32 s25, s25, s26
  s_mov_b32 s95, s24
  s_lshl_b32 s26, s4, 12
  s_and_b32 s26, s26, 0x1000
  s_lshl_b32 s27, s4, 14
  s_and_b32 s27, s27, 0x8000
  s_add_u32 s27, s27, 86016
  s_add_u32 s91, s27, s26
  s_lshl_b32 s28, s24, 15
  s_add_u32 s93, s28, s26
  s_lshr_b32 s26, s26, 1
  s_add_u32 s92, s27, s26
  s_add_u32 s94, s28, s26
  s_mul_i32 s84, s24, 28672
  s_lshl_b32 s26, s25, 11
  s_add_u32 s84, s84, s26
  s_lshl_b32 s85, s25, 14
  s_lshl_b32 s26, s24, 8
  s_add_u32 s85, s85, s26
  s_lshl_b32 s86, s40, 2
  s_add_u32 s86, s86, s4
  s_lshl_b32 s86, s86, 15
  s_lshl_b32 s26, s41, 11
  s_add_u32 s86, s86, s26
  s_lshl_b32 s46, s2, 7
  s_add_u32 s46, s46, 15466496
  s_mov_b32 s47, 0
  s_mov_b32 s90, 0
  s_getreg_b32 s45, hwreg(HW_REG_XCC_ID, 0, 4)
  s_add_u32 s45, s45, 1
  s_mov_b32 s44, 0
  s_mov_b32 s62, 0
  s_mov_b32 s63, 0
  s_mov_b32 s11, 0x20000
  s_mov_b32 s35, 0x20000
  s_mov_b32 s39, 0x20000
  s_mov_b32 s75, 0x20000
  s_mov_b32 s79, 0x20000
  s_mov_b32 s83, 0x20000
  s_mov_b32 s10, 268435456
  s_mov_b32 s34, 1835008
  s_mov_b32 s38, 256
  s_mov_b32 s74, 1204224
  s_mov_b32 s78, 401408
  s_mov_b32 s82, 401408
  v_add_u32 v14, 65536, v1
  v_cmp_eq_u32 vcc, 28, v2
  v_mov_b32 v15, 1065369472
  s_nop 0
  v_cndmask_b32 v15, 0, v15, vcc
  s_and_b32 s9, s9, 0xffff
  s_and_b32 s33, s33, 0xffff
  s_and_b32 s37, s37, 0xffff
  s_and_b32 s73, s73, 0xffff
  s_and_b32 s77, s77, 0xffff
  s_and_b32 s81, s81, 0xffff
  s_cmp_lt_u32 s2, 243
  s_cbranch_scc1 z_2
  s_sub_u32 s3, s2, 243
  s_lshl_b32 s53, s3, 14
  s_add_u32 s53, s53, 15335424
  v_lshlrev_b32 v16, 4, v0
  v_mov_b32 v20, 0
  v_mov_b32 v21, 0
  v_mov_b32 v22, 0
  v_mov_b32 v23, 0
  buffer_store_dwordx4 v[20:23], v16, s[8:11], s53 offen sc1
  s_add_u32 s53, s53, 4096
  buffer_store_dwordx4 v[20:23], v16, s[8:11], s53 offen sc1
  s_add_u32 s53, s53, 4096
  buffer_store_dwordx4 v[20:23], v16, s[8:11], s53 offen sc1
  s_add_u32 s53, s53, 4096
  buffer_store_dwordx4 v[20:23], v16, s[8:11], s53 offen sc1
  s_lshl_b32 s3, s3, 2
z_2:
  s_lshl_b32 s13, s4, 12
  s_add_u32 s13, s13, 143360
  v_bfe_u32 v218, v2, 1, 3
  v_lshl_add_u32 v219, v2, 7, s21
  v_lshl_add_u32 v219, v3, 3, v219
  v_xor_b32 v220, 0, v218
  v_lshl_add_u32 v166, v220, 4, v219
  v_xor_b32 v220, 1, v218
  v_lshl_add_u32 v167, v220, 4, v219
  v_xor_b32 v220, 2, v218
  v_lshl_add_u32 v168, v220, 4, v219
  v_xor_b32 v220, 3, v218
  v_lshl_add_u32 v169, v220, 4, v219
  v_xor_b32 v220, 4, v218
  v_lshl_add_u32 v170, v220, 4, v219
  v_xor_b32 v220, 5, v218
  v_lshl_add_u32 v171, v220, 4, v219
  v_xor_b32 v220, 6, v218
  v_lshl_add_u32 v172, v220, 4, v219
  v_xor_b32 v220, 7, v218
  v_lshl_add_u32 v173, v220, 4, v219
  v_and_b32 v218, 0xc0, v1
  v_lshl_add_u32 v218, v3, 8, v218
  v_bfe_u32 v219, v1, 8, 1
  v_lshl_add_u32 v218, v219, 5, v218
  v_bfe_u32 v219, v1, 4, 2
  v_lshl_add_u32 v218, v219, 3, v218
  v_add_u32 v242, s14, v218
  v_add_u32 v243, 65536, v242
  s_xor_b32 s50, s41, 1
  s_xor_b32 s24, s14, 8
  s_add_u32 s24, s24, s13
  v_add_u32 v218, s24, v218
  s_mul_i32 s24, s14, 12
  s_sub_u32 s24, 48, s24
  v_add_u32 v217, s24, v174
  v_lshlrev_b32 v244, 2, v2
  v_lshrrev_b32 v4, 2, v1
  s_mov_b32 s19, 1065369472
  v_mov_b32 v160, 0
  v_mov_b32 v161, 0
  s_lshl_b32 s18, s4, 7
  s_add_u32 s18, s18, 159744
  v_lshl_add_u32 v240, v2, 2, s18
  v_lshl_add_u32 v241, v3, 4, s18
  s_mov_b32 s17, 0x07060302
  v_add_u32 v245, s15, v242
  v_add_u32 v246, s15, v243
  v_mov_b32 v247, 0
  v_mov_b32 v248, 0
  s_mul_i32 s24, s23, 172032
  s_add_u32 s24, s24, s22
  s_add_u32 m0, s15, 13312
  s_add_u32 s24, s24, 896
  buffer_load_dwordx4 v174, s[68:71], s24 offen lds
  s_add_u32 m0, s15, 14336
  s_add_u32 s24, s24, 896
  buffer_load_dwordx4 v174, s[68:71], s24 offen lds
  s_add_u32 m0, s21, 4096
  s_lshl_b32 s24, s23, 7
  s_add_u32 s24, s24, s20
  buffer_load_dwordx4 v164, s[64:67], s24 offen offset:0 lds
  s_add_u32 s24, s24, 6144
  buffer_load_dwordx4 v165, s[64:67], s24 offen offset:1024 lds
  s_add_u32 s24, s24, 6144
  buffer_load_dwordx4 v164, s[64:67], s24 offen offset:2048 lds
  s_add_u32 s24, s24, 6144
  buffer_load_dwordx4 v165, s[64:67], s24 offen offset:3072 lds
  s_add_u32 s23, s23, 1
  s_cmp_eq_u32 s23, 7
  s_cselect_b32 s23, 0, s23
  s_waitcnt vmcnt(6)
  s_barrier
  s_cmp_lt_u32 s2, 243
  s_cbranch_scc1 z_3
  s_cmp_lg_u32 s4, 0
  s_cbranch_scc1 z_3
  v_mov_b32 v5, 1
  v_mov_b32 v6, 0
  s_mov_b64 exec, 1
  buffer_store_dword v5, v6, s[36:39], s3 offen sc1
  s_mov_b64 exec, -1
z_3:
  ds_read_b64 v[16:17], v166 offset:0
  ds_read_b64 v[18:19], v167 offset:0
  ds_read_b64 v[20:21], v168 offset:0
  ds_read_b64 v[22:23], v169 offset:0
  ds_read_b64 v[24:25], v170 offset:0
  ds_read_b64 v[26:27], v171 offset:0
  ds_read_b64 v[28:29], v172 offset:0
  ds_read_b64 v[30:31], v173 offset:0
  ds_read_b64_tr_b16 v[228:229], v245 offset:1024
  ds_read_b64_tr_b16 v[230:231], v245 offset:1536
  ds_read_b64_tr_b16 v[236:237], v245 offset:2048
  ds_read_b64_tr_b16 v[238:239], v245 offset:2560
  ds_read_b64_tr_b16 v[176:177], v242 offset:1024
  ds_read_b64_tr_b16 v[178:179], v242 offset:1536
  ds_read_b64_tr_b16 v[180:181], v242 offset:2048
  ds_read_b64_tr_b16 v[182:183], v242 offset:2560
  ds_read_b64_tr_b16 v[184:185], v242 offset:4096
  ds_read_b64_tr_b16 v[186:187], v242 offset:4608
  ds_read_b64_tr_b16 v[188:189], v242 offset:5120
  ds_read_b64_tr_b16 v[190:191], v242 offset:5632
  s_waitcnt lgkmcnt(15)
  v_dot2_f32_bf16 v160, v16, s19, v160
  v_dot2_f32_bf16 v161, v16, v16, v161
  v_dot2_f32_bf16 v160, v17, s19, v160
  v_dot2_f32_bf16 v161, v17, v17, v161
  v_dot2_f32_bf16 v160, v18, s19, v160
  v_dot2_f32_bf16 v161, v18, v18, v161
  v_dot2_f32_bf16 v160, v19, s19, v160
  v_dot2_f32_bf16 v161, v19, v19, v161
  v_dot2_f32_bf16 v160, v20, s19, v160
  v_dot2_f32_bf16 v161, v20, v20, v161
  v_dot2_f32_bf16 v160, v21, s19, v160
  v_dot2_f32_bf16 v161, v21, v21, v161
  v_dot2_f32_bf16 v160, v22, s19, v160
  v_dot2_f32_bf16 v161, v22, v22, v161
  v_dot2_f32_bf16 v160, v23, s19, v160
  v_dot2_f32_bf16 v161, v23, v23, v161
  v_dot2_f32_bf16 v160, v24, s19, v160
  v_dot2_f32_bf16 v161, v24, v24, v161
  v_dot2_f32_bf16 v160, v25, s19, v160
  v_dot2_f32_bf16 v161, v25, v25, v161
  s_waitcnt lgkmcnt(14)
  v_dot2_f32_bf16 v160, v26, s19, v160
  v_dot2_f32_bf16 v161, v26, v26, v161
  v_dot2_f32_bf16 v160, v27, s19, v160
  v_dot2_f32_bf16 v161, v27, v27, v161
  s_waitcnt lgkmcnt(13)
  v_dot2_f32_bf16 v160, v28, s19, v160
  v_dot2_f32_bf16 v161, v28, v28, v161
  v_dot2_f32_bf16 v160, v29, s19, v160
  v_dot2_f32_bf16 v161, v29, v29, v161
  s_waitcnt lgkmcnt(12)
  v_dot2_f32_bf16 v160, v30, s19, v160
  v_dot2_f32_bf16 v161, v30, v30, v161
  v_dot2_f32_bf16 v160, v31, s19, v160
  v_dot2_f32_bf16 v161, v31, v31, v161
  s_waitcnt lgkmcnt(11)
  v_dot2_f32_bf16 v247, v228, s19, v247
  s_waitcnt lgkmcnt(9)
  v_dot2_f32_bf16 v248, v236, s19, v248
  v_dot2_f32_bf16 v247, v229, s19, v247
  v_dot2_f32_bf16 v248, v237, s19, v248
  v_dot2_f32_bf16 v247, v230, s19, v247
  s_waitcnt lgkmcnt(8)
  v_dot2_f32_bf16 v248, v238, s19, v248
  v_dot2_f32_bf16 v247, v231, s19, v247
  v_dot2_f32_bf16 v248, v239, s19, v248
  s_waitcnt lgkmcnt(6)
  v_mfma_f32_32x32x16_bf16 v[128:143], v[16:19], v[176:179], 0
  s_mul_i32 s24, s23, 172032
  s_add_u32 s24, s24, s22
  s_add_u32 m0, s15, 25600
  s_add_u32 s24, s24, 896
  buffer_load_dwordx4 v174, s[68:71], s24 offen lds
  s_add_u32 m0, s15, 26624
  s_add_u32 s24, s24, 896
  buffer_load_dwordx4 v174, s[68:71], s24 offen lds
  ds_read_b64_tr_b16 v[192:193], v242 offset:7168
  ds_read_b64_tr_b16 v[194:195], v242 offset:7680
  s_waitcnt lgkmcnt(6)
  v_mfma_f32_32x32x16_bf16 v[144:159], v[16:19], v[180:183], 0
  s_add_u32 m0, s21, 8192
  s_lshl_b32 s24, s23, 7
  s_add_u32 s24, s24, s20
  buffer_load_dwordx4 v164, s[64:67], s24 offen offset:0 lds
  s_add_u32 s24, s24, 6144
  buffer_load_dwordx4 v165, s[64:67], s24 offen offset:1024 lds
  s_add_u32 s24, s24, 6144
  buffer_load_dwordx4 v164, s[64:67], s24 offen offset:2048 lds
  s_add_u32 s24, s24, 6144
  buffer_load_dwordx4 v165, s[64:67], s24 offen offset:3072 lds
  s_add_u32 s23, s23, 1
  s_cmp_eq_u32 s23, 7
  s_cselect_b32 s23, 0, s23
  ds_read_b64_tr_b16 v[196:197], v242 offset:8192
  ds_read_b64_tr_b16 v[198:199], v242 offset:8704
  s_waitcnt lgkmcnt(6)
  v_mfma_f32_32x32x16_bf16 v[128:143], v[20:23], v[184:187], v[128:143]
  ds_read_b64_tr_b16 v[176:177], v242 offset:10240
  ds_read_b64_tr_b16 v[178:179], v242 offset:10752
  s_waitcnt lgkmcnt(6)
  v_mfma_f32_32x32x16_bf16 v[144:159], v[20:23], v[188:191], v[144:159]
  s_waitcnt vmcnt(6)
  s_barrier
  ds_read_b64 v[32:33], v166 offset:4096
  ds_read_b64 v[34:35], v167 offset:4096
  ds_read_b64 v[36:37], v168 offset:4096
  ds_read_b64 v[38:39], v169 offset:4096
  ds_read_b64 v[40:41], v170 offset:4096
  ds_read_b64 v[42:43], v171 offset:4096
  ds_read_b64 v[44:45], v172 offset:4096
  ds_read_b64 v[46:47], v173 offset:4096
  ds_read_b64_tr_b16 v[228:229], v245 offset:13312
  ds_read_b64_tr_b16 v[230:231], v245 offset:13824
  ds_read_b64_tr_b16 v[236:237], v245 offset:14336
  ds_read_b64_tr_b16 v[238:239], v245 offset:14848
  ds_read_b64_tr_b16 v[180:181], v242 offset:11264
  ds_read_b64_tr_b16 v[182:183], v242 offset:11776
  s_waitcnt lgkmcnt(15)
  v_mfma_f32_32x32x16_bf16 v[128:143], v[24:27], v[192:195], v[128:143]
  s_add_u32 s24, s7, 0
  s_mul_i32 s25, s24, 171
  s_lshr_b32 s25, s25, 9
  s_mul_i32 s26, s25, 45
  s_add_u32 s26, s26, s24
  s_mul_i32 s26, s26, 896
  s_add_u32 m0, s13, 0
  s_nop 0
  buffer_load_dwordx4 v217, s[68:71], s26 offen lds
  s_add_u32 m0, s13, 1024
  s_nop 0
  buffer_load_dwordx4 v217, s[72:75], s26 offen lds
  s_mul_i32 s25, s25, 3
  s_sub_u32 s25, s24, s25
  s_mul_i32 s30, s50, 3
  s_add_u32 s30, s30, s25
  s_lshl_b32 s30, s30, 7
  s_add_u32 s30, s30, 15532032
  s_lshl_b32 s25, s24, 10
  s_mul_i32 s28, s50, 86016
  s_add_u32 s28, s28, s25
  s_add_u32 s28, s28, 12582912
  s_add_u32 s24, s7, 64
  s_mul_i32 s25, s24, 171
  s_lshr_b32 s25, s25, 9
  s_mul_i32 s26, s25, 45
  s_add_u32 s26, s26, s24
  s_mul_i32 s26, s26, 896
  s_cmp_ge_u32 s24, 84
  s_cselect_b32 s26, 1073741824, s26
  s_add_u32 m0, s13, 2048
  s_nop 0
  buffer_load_dwordx4 v217, s[68:71], s26 offen lds
  s_add_u32 m0, s13, 3072
  s_nop 0
  buffer_load_dwordx4 v217, s[72:75], s26 offen lds
  s_mul_i32 s25, s25, 3
  s_sub_u32 s25, s24, s25
  s_mul_i32 s31, s50, 3
  s_add_u32 s31, s31, s25
  s_lshl_b32 s31, s31, 7
  s_add_u32 s31, s31, 15532032
  s_lshl_b32 s25, s24, 10
  s_mul_i32 s29, s50, 86016
  s_add_u32 s29, s29, s25
  s_add_u32 s29, s29, 12582912
  s_cmp_ge_u32 s24, 84
  s_cselect_b32 s29, 1073741824, s29
  s_cselect_b32 s31, 1073741824, s31
  ds_read_b64_tr_b16 v[184:185], v242 offset:13312
  ds_read_b64_tr_b16 v[186:187], v242 offset:13824
  v_mfma_f32_32x32x16_bf16 v[144:159], v[24:27], v[196:199], v[144:159]
  s_mul_i32 s24, s23, 172032
  s_add_u32 s24, s24, s22
  s_add_u32 m0, s15, 37888
  s_add_u32 s24, s24, 896
  buffer_load_dwordx4 v174, s[68:71], s24 offen lds
  s_add_u32 m0, s15, 38912
  s_add_u32 s24, s24, 896
  buffer_load_dwordx4 v174, s[68:71], s24 offen lds
  ds_read_b64_tr_b16 v[188:189], v242 offset:14336
  ds_read_b64_tr_b16 v[190:191], v242 offset:14848
  s_waitcnt lgkmcnt(15)
  v_mfma_f32_32x32x16_bf16 v[128:143], v[28:31], v[176:179], v[128:143]
  ds_read_b64_tr_b16 v[192:193], v242 offset:16384
  ds_read_b64_tr_b16 v[194:195], v242 offset:16896
  s_waitcnt lgkmcnt(6)
  v_mfma_f32_32x32x16_bf16 v[144:159], v[28:31], v[180:183], v[144:159]
  s_add_u32 m0, s21, 0
  s_lshl_b32 s24, s23, 7
  s_add_u32 s24, s24, s20
  buffer_load_dwordx4 v164, s[64:67], s24 offen offset:0 lds
  s_add_u32 s24, s24, 6144
  buffer_load_dwordx4 v165, s[64:67], s24 offen offset:1024 lds
  s_add_u32 s24, s24, 6144
  buffer_load_dwordx4 v164, s[64:67], s24 offen offset:2048 lds
  s_add_u32 s24, s24, 6144
  buffer_load_dwordx4 v165, s[64:67], s24 offen offset:3072 lds
  s_add_u32 s23, s23, 1
  s_cmp_eq_u32 s23, 7
  s_cselect_b32 s23, 0, s23
  ds_read_b64_tr_b16 v[196:197], v242 offset:17408
  ds_read_b64_tr_b16 v[198:199], v242 offset:17920
  v_dot2_f32_bf16 v160, v32, s19, v160
  v_dot2_f32_bf16 v161, v32, v32, v161
  v_dot2_f32_bf16 v160, v33, s19, v160
  v_dot2_f32_bf16 v161, v33, v33, v161
  v_dot2_f32_bf16 v160, v34, s19, v160
  v_dot2_f32_bf16 v161, v34, v34, v161
  v_dot2_f32_bf16 v160, v35, s19, v160
  v_dot2_f32_bf16 v161, v35, v35, v161
  v_dot2_f32_bf16 v160, v36, s19, v160
  v_dot2_f32_bf16 v161, v36, v36, v161
  v_dot2_f32_bf16 v160, v37, s19, v160
  v_dot2_f32_bf16 v161, v37, v37, v161
  v_dot2_f32_bf16 v160, v38, s19, v160
  v_dot2_f32_bf16 v161, v38, v38, v161
  v_dot2_f32_bf16 v160, v39, s19, v160
  v_dot2_f32_bf16 v161, v39, v39, v161
  v_dot2_f32_bf16 v160, v40, s19, v160
  v_dot2_f32_bf16 v161, v40, v40, v161
  v_dot2_f32_bf16 v160, v41, s19, v160
  v_dot2_f32_bf16 v161, v41, v41, v161
  v_dot2_f32_bf16 v160, v42, s19, v160
  v_dot2_f32_bf16 v161, v42, v42, v161
  v_dot2_f32_bf16 v160, v43, s19, v160
  v_dot2_f32_bf16 v161, v43, v43, v161
  v_dot2_f32_bf16 v160, v44, s19, v160
  v_dot2_f32_bf16 v161, v44, v44, v161
  v_dot2_f32_bf16 v160, v45, s19, v160
  v_dot2_f32_bf16 v161, v45, v45, v161
  v_dot2_f32_bf16 v160, v46, s19, v160
  v_dot2_f32_bf16 v161, v46, v46, v161
  v_dot2_f32_bf16 v160, v47, s19, v160
  v_dot2_f32_bf16 v161, v47, v47, v161
  v_dot2_f32_bf16 v247, v228, s19, v247
  v_dot2_f32_bf16 v248, v236, s19, v248
  v_dot2_f32_bf16 v247, v229, s19, v247
  v_dot2_f32_bf16 v248, v237, s19, v248
  v_dot2_f32_bf16 v247, v230, s19, v247
  v_dot2_f32_bf16 v248, v238, s19, v248
  v_dot2_f32_bf16 v247, v231, s19, v247
  v_dot2_f32_bf16 v248, v239, s19, v248
  s_waitcnt lgkmcnt(6)
  v_mfma_f32_32x32x16_bf16 v[128:143], v[32:35], v[184:187], v[128:143]
  ds_read_b64_tr_b16 v[176:177], v242 offset:19456
  ds_read_b64_tr_b16 v[178:179], v242 offset:19968
  s_waitcnt lgkmcnt(6)
  v_mfma_f32_32x32x16_bf16 v[144:159], v[32:35], v[188:191], v[144:159]
  ds_read_b64_tr_b16 v[180:181], v242 offset:20480
  ds_read_b64_tr_b16 v[182:183], v242 offset:20992
  s_waitcnt lgkmcnt(6)
  v_mfma_f32_32x32x16_bf16 v[128:143], v[36:39], v[192:195], v[128:143]
  ds_read_b64_tr_b16 v[184:185], v242 offset:22528
  ds_read_b64_tr_b16 v[186:187], v242 offset:23040
  s_waitcnt lgkmcnt(6)
  v_mfma_f32_32x32x16_bf16 v[144:159], v[36:39], v[196:199], v[144:159]
  s_waitcnt vmcnt(10)
  s_barrier
  ds_read_b64 v[48:49], v166 offset:8192
  ds_read_b64 v[50:51], v167 offset:8192
  ds_read_b64 v[52:53], v168 offset:8192
  ds_read_b64 v[54:55], v169 offset:8192
  ds_read_b64 v[56:57], v170 offset:8192
  ds_read_b64 v[58:59], v171 offset:8192
  ds_read_b64 v[60:61], v172 offset:8192
  ds_read_b64 v[62:63], v173 offset:8192
  ds_read_b64_tr_b16 v[228:229], v245 offset:25600
  ds_read_b64_tr_b16 v[230:231], v245 offset:26112
  ds_read_b64_tr_b16 v[236:237], v245 offset:26624
  ds_read_b64_tr_b16 v[238:239], v245 offset:27136
  ds_read_b64_tr_b16 v[188:189], v242 offset:23552
  ds_read_b64_tr_b16 v[190:191], v242 offset:24064
  s_waitcnt lgkmcnt(15)
  v_mfma_f32_32x32x16_bf16 v[128:143], v[40:43], v[176:179], v[128:143]
  s_waitcnt vmcnt(6)
  ds_read_b64_tr_b16 v[200:201], v218 offset:0
  ds_read_b64_tr_b16 v[202:203], v218 offset:512
  ds_read_b64_tr_b16 v[204:205], v218 offset:1024
  ds_read_b64_tr_b16 v[206:207], v218 offset:1536
  ds_read_b64_tr_b16 v[208:209], v218 offset:2048
  ds_read_b64_tr_b16 v[210:211], v218 offset:2560
  ds_read_b64_tr_b16 v[212:213], v218 offset:3072
  ds_read_b64_tr_b16 v[214:215], v218 offset:3584
  ds_read_b64_tr_b16 v[192:193], v242 offset:25600
  ds_read_b64_tr_b16 v[194:195], v242 offset:26112
  v_mfma_f32_32x32x16_bf16 v[144:159], v[40:43], v[180:183], v[144:159]
  s_mul_i32 s24, s23, 172032
  s_add_u32 s24, s24, s22
  s_add_u32 m0, s15, 50176
  s_add_u32 s24, s24, 896
  buffer_load_dwordx4 v174, s[68:71], s24 offen lds
  s_add_u32 m0, s15, 51200
  s_add_u32 s24, s24, 896
  buffer_load_dwordx4 v174, s[68:71], s24 offen lds
  ds_read_b64_tr_b16 v[196:197], v242 offset:26624
  ds_read_b64_tr_b16 v[198:199], v242 offset:27136
  s_waitcnt lgkmcnt(15)
  v_mfma_f32_32x32x16_bf16 v[128:143], v[44:47], v[184:187], v[128:143]
  s_add_u32 m0, s21, 4096
  s_lshl_b32 s24, s23, 7
  s_add_u32 s24, s24, s20
  buffer_load_dwordx4 v164, s[64:67], s24 offen offset:0 lds
  s_add_u32 s24, s24, 6144
  buffer_load_dwordx4 v165, s[64:67], s24 offen offset:1024 lds
  s_add_u32 s24, s24, 6144
  buffer_load_dwordx4 v164, s[64:67], s24 offen offset:2048 lds
  s_add_u32 s24, s24, 6144
  buffer_load_dwordx4 v165, s[64:67], s24 offen offset:3072 lds
  s_add_u32 s23, s23, 1
  s_cmp_eq_u32 s23, 7
  s_cselect_b32 s23, 0, s23
  ds_read_b64_tr_b16 v[176:177], v242 offset:28672
  ds_read_b64_tr_b16 v[178:179], v242 offset:29184
  s_waitcnt lgkmcnt(14)
  v_mfma_f32_32x32x16_bf16 v[144:159], v[44:47], v[188:191], v[144:159]
  s_waitcnt lgkmcnt(12)
  buffer_store_dwordx4 v[200:203], v1, s[8:11], s28 offen sc1
  s_add_u32 s28, s28, 1376256
  s_waitcnt lgkmcnt(10)
  buffer_store_dwordx4 v[204:207], v1, s[8:11], s28 offen sc1
  s_waitcnt lgkmcnt(8)
  buffer_store_dwordx4 v[208:211], v1, s[8:11], s29 offen sc1
  s_add_u32 s29, s29, 1376256
  s_waitcnt lgkmcnt(6)
  buffer_store_dwordx4 v[212:215], v1, s[8:11], s29 offen sc1
  ds_read_b64_tr_b16 v[180:181], v242 offset:29696
  ds_read_b64_tr_b16 v[182:183], v242 offset:30208
  v_dot2_f32_bf16 v160, v48, s19, v160
  v_dot2_f32_bf16 v161, v48, v48, v161
  v_dot2_f32_bf16 v160, v49, s19, v160
  v_dot2_f32_bf16 v161, v49, v49, v161
  v_dot2_f32_bf16 v160, v50, s19, v160
  v_dot2_f32_bf16 v161, v50, v50, v161
  v_dot2_f32_bf16 v160, v51, s19, v160
  v_dot2_f32_bf16 v161, v51, v51, v161
  v_dot2_f32_bf16 v160, v52, s19, v160
  v_dot2_f32_bf16 v161, v52, v52, v161
  v_dot2_f32_bf16 v160, v53, s19, v160
  v_dot2_f32_bf16 v161, v53, v53, v161
  v_dot2_f32_bf16 v160, v54, s19, v160
  v_dot2_f32_bf16 v161, v54, v54, v161
  v_dot2_f32_bf16 v160, v55, s19, v160
  v_dot2_f32_bf16 v161, v55, v55, v161
  v_dot2_f32_bf16 v160, v56, s19, v160
  v_dot2_f32_bf16 v161, v56, v56, v161
  v_dot2_f32_bf16 v160, v57, s19, v160
  v_dot2_f32_bf16 v161, v57, v57, v161
  v_dot2_f32_bf16 v160, v58, s19, v160
  v_dot2_f32_bf16 v161, v58, v58, v161
  v_dot2_f32_bf16 v160, v59, s19, v160
  v_dot2_f32_bf16 v161, v59, v59, v161
  v_dot2_f32_bf16 v160, v60, s19, v160
  v_dot2_f32_bf16 v161, v60, v60, v161
  v_dot2_f32_bf16 v160, v61, s19, v160
  v_dot2_f32_bf16 v161, v61, v61, v161
  v_dot2_f32_bf16 v160, v62, s19, v160
  v_dot2_f32_bf16 v161, v62, v62, v161
  v_dot2_f32_bf16 v160, v63, s19, v160
  v_dot2_f32_bf16 v161, v63, v63, v161
  v_dot2_f32_bf16 v247, v228, s19, v247
  v_dot2_f32_bf16 v248, v236, s19, v248
  v_dot2_f32_bf16 v247, v229, s19, v247
  v_dot2_f32_bf16 v248, v237, s19, v248
  v_dot2_f32_bf16 v247, v230, s19, v247
  v_dot2_f32_bf16 v248, v238, s19, v248
  v_dot2_f32_bf16 v247, v231, s19, v247
  v_dot2_f32_bf16 v248, v239, s19, v248
  v_dot2_f32_bf16 v220, v200, s19, 0
  v_dot2_f32_bf16 v221, v204, s19, 0
  v_dot2_f32_bf16 v222, v208, s19, 0
  v_dot2_f32_bf16 v223, v212, s19, 0
  v_dot2_f32_bf16 v220, v201, s19, v220
  v_dot2_f32_bf16 v221, v205, s19, v221
  v_dot2_f32_bf16 v222, v209, s19, v222
  v_dot2_f32_bf16 v223, v213, s19, v223
  v_dot2_f32_bf16 v220, v202, s19, v220
  v_dot2_f32_bf16 v221, v206, s19, v221
  v_dot2_f32_bf16 v222, v210, s19, v222
  v_dot2_f32_bf16 v223, v214, s19, v223
  v_dot2_f32_bf16 v220, v203, s19, v220
  v_dot2_f32_bf16 v221, v207, s19, v221
  v_dot2_f32_bf16 v222, v211, s19, v222
  v_dot2_f32_bf16 v223, v215, s19, v223
  s_waitcnt lgkmcnt(6)
  v_mfma_f32_32x32x16_bf16 v[128:143], v[48:51], v[192:195], v[128:143]
  buffer_load_dword v6, v4, s[36:39], 0 offen sc1
  ds_read_b64_tr_b16 v[184:185], v242 offset:31744
  ds_read_b64_tr_b16 v[186:187], v242 offset:32256
  v_mov_b32 v224, v220
  v_mov_b32 v225, v221
  v_mov_b32 v226, v222
  v_mov_b32 v227, v223
  s_waitcnt lgkmcnt(6)
  v_mfma_f32_32x32x16_bf16 v[144:159], v[48:51], v[196:199], v[144:159]
  ds_read_b64_tr_b16 v[188:189], v242 offset:32768
  ds_read_b64_tr_b16 v[190:191], v242 offset:33280
  v_permlane32_swap_b32 v220, v224
  v_permlane32_swap_b32 v221, v225
  v_permlane32_swap_b32 v222, v226
  v_permlane32_swap_b32 v223, v227
  s_waitcnt lgkmcnt(6)
  v_mfma_f32_32x32x16_bf16 v[128:143], v[52:55], v[176:179], v[128:143]
  ds_read_b64_tr_b16 v[192:193], v242 offset:34816
  ds_read_b64_tr_b16 v[194:195], v242 offset:35328
  v_add_f32 v220, v220, v224
  v_add_f32 v221, v221, v225
  v_add_f32 v222, v222, v226
  v_add_f32 v223, v223, v227
  s_waitcnt lgkmcnt(6)
  v_mfma_f32_32x32x16_bf16 v[144:159], v[52:55], v[180:183], v[144:159]
  s_waitcnt vmcnt(11)
  s_barrier
  ds_read_b64 v[64:65], v166 offset:0
  ds_read_b64 v[66:67], v167 offset:0
  ds_read_b64 v[68:69], v168 offset:0
  ds_read_b64 v[70:71], v169 offset:0
  ds_read_b64 v[72:73], v170 offset:0
  ds_read_b64 v[74:75], v171 offset:0
  ds_read_b64 v[76:77], v172 offset:0
  ds_read_b64 v[78:79], v173 offset:0
  ds_read_b64_tr_b16 v[228:229], v245 offset:37888
  ds_read_b64_tr_b16 v[230:231], v245 offset:38400
  ds_read_b64_tr_b16 v[236:237], v245 offset:38912
  ds_read_b64_tr_b16 v[238:239], v245 offset:39424
  ds_read_b64_tr_b16 v[196:197], v242 offset:35840
  ds_read_b64_tr_b16 v[198:199], v242 offset:36352
  s_waitcnt lgkmcnt(15)
  v_mfma_f32_32x32x16_bf16 v[128:143], v[56:59], v[184:187], v[128:143]
  ds_read_b64_tr_b16 v[176:177], v242 offset:37888
  ds_read_b64_tr_b16 v[178:179], v242 offset:38400
  v_mfma_f32_32x32x16_bf16 v[144:159], v[56:59], v[188:191], v[144:159]
  s_mul_i32 s24, s23, 172032
  s_add_u32 s24, s24, s22
  s_add_u32 m0, s15, 62464
  s_add_u32 s24, s24, 896
  buffer_load_dwordx4 v174, s[68:71], s24 offen lds
  s_add_u32 m0, s15, 63488
  s_add_u32 s24, s24, 896
  buffer_load_dwordx4 v174, s[68:71], s24 offen lds
  ds_read_b64_tr_b16 v[180:181], v242 offset:38912
  ds_read_b64_tr_b16 v[182:183], v242 offset:39424
  s_waitcnt lgkmcnt(15)
  v_mfma_f32_32x32x16_bf16 v[128:143], v[60:63], v[192:195], v[128:143]
  s_add_u32 m0, s21, 8192
  s_lshl_b32 s24, s23, 7
  s_add_u32 s24, s24, s20
  buffer_load_dwordx4 v164, s[64:67], s24 offen offset:0 lds
  s_add_u32 s24, s24, 6144
  buffer_load_dwordx4 v165, s[64:67], s24 offen offset:1024 lds
  s_add_u32 s24, s24, 6144
  buffer_load_dwordx4 v164, s[64:67], s24 offen offset:2048 lds
  s_add_u32 s24, s24, 6144
  buffer_load_dwordx4 v165, s[64:67], s24 offen offset:3072 lds
  s_add_u32 s23, s23, 1
  s_cmp_eq_u32 s23, 7
  s_cselect_b32 s23, 0, s23
  ds_read_b64_tr_b16 v[184:185], v242 offset:40960
  ds_read_b64_tr_b16 v[186:187], v242 offset:41472
  s_waitcnt lgkmcnt(6)
  v_mfma_f32_32x32x16_bf16 v[144:159], v[60:63], v[196:199], v[144:159]
  ds_read_b64_tr_b16 v[188:189], v242 offset:41984
  ds_read_b64_tr_b16 v[190:191], v242 offset:42496
  v_dot2_f32_bf16 v160, v64, s19, v160
  v_dot2_f32_bf16 v161, v64, v64, v161
  v_dot2_f32_bf16 v160, v65, s19, v160
  v_dot2_f32_bf16 v161, v65, v65, v161
  v_dot2_f32_bf16 v160, v66, s19, v160
  v_dot2_f32_bf16 v161, v66, v66, v161
  v_dot2_f32_bf16 v160, v67, s19, v160
  v_dot2_f32_bf16 v161, v67, v67, v161
  v_dot2_f32_bf16 v160, v68, s19, v160
  v_dot2_f32_bf16 v161, v68, v68, v161
  v_dot2_f32_bf16 v160, v69, s19, v160
  v_dot2_f32_bf16 v161, v69, v69, v161
  v_dot2_f32_bf16 v160, v70, s19, v160
  v_dot2_f32_bf16 v161, v70, v70, v161
  v_dot2_f32_bf16 v160, v71, s19, v160
  v_dot2_f32_bf16 v161, v71, v71, v161
  v_dot2_f32_bf16 v160, v72, s19, v160
  v_dot2_f32_bf16 v161, v72, v72, v161
  v_dot2_f32_bf16 v160, v73, s19, v160
  v_dot2_f32_bf16 v161, v73, v73, v161
  v_dot2_f32_bf16 v160, v74, s19, v160
  v_dot2_f32_bf16 v161, v74, v74, v161
  v_dot2_f32_bf16 v160, v75, s19, v160
  v_dot2_f32_bf16 v161, v75, v75, v161
  v_dot2_f32_bf16 v160, v76, s19, v160
  v_dot2_f32_bf16 v161, v76, v76, v161
  v_dot2_f32_bf16 v160, v77, s19, v160
  v_dot2_f32_bf16 v161, v77, v77, v161
  v_dot2_f32_bf16 v160, v78, s19, v160
  v_dot2_f32_bf16 v161, v78, v78, v161
  v_dot2_f32_bf16 v160, v79, s19, v160
  v_dot2_f32_bf16 v161, v79, v79, v161
  v_dot2_f32_bf16 v247, v228, s19, v247
  v_dot2_f32_bf16 v248, v236, s19, v248
  v_dot2_f32_bf16 v247, v229, s19, v247
  v_dot2_f32_bf16 v248, v237, s19, v248
  v_dot2_f32_bf16 v247, v230, s19, v247
  v_dot2_f32_bf16 v248, v238, s19, v248
  v_dot2_f32_bf16 v247, v231, s19, v247
  v_dot2_f32_bf16 v248, v239, s19, v248
  s_waitcnt lgkmcnt(6)
  v_mfma_f32_32x32x16_bf16 v[128:143], v[64:67], v[176:179], v[128:143]
  s_waitcnt vmcnt(6)
  v_cmp_le_u32 vcc, 1, v6
  s_mov_b32 s58, 8191
  s_mov_b32 s59, 0
  s_and_b64 vcc, vcc, s[58:59]
  s_cmp_eq_u64 vcc, s[58:59]
  s_cbranch_scc1 look_4
  s_mov_b64 exec, s[58:59]
  s_mov_b32 s48, 400000
  s_waitcnt lgkmcnt(0)
poll_5:
  buffer_load_dword v6, v4, s[36:39], 0 offen sc1
  s_sub_u32 s48, s48, 1
  s_cbranch_scc1 k_end
  s_waitcnt vmcnt(0)
  v_cmp_le_u32 vcc, 1, v6
  s_nop 0
  s_cmp_eq_u64 vcc, exec
  s_cbranch_scc0 poll_5
  s_mov_b64 exec, -1
look_4:
  s_mov_b32 exec_hi, 0
  buffer_atomic_add_f32 v220, v244, s[8:11], s30 offen sc1
  s_add_u32 s30, s30, 6144
  buffer_atomic_add_f32 v221, v244, s[8:11], s30 offen sc1
  buffer_atomic_add_f32 v222, v244, s[8:11], s31 offen sc1
  s_add_u32 s31, s31, 6144
  buffer_atomic_add_f32 v223, v244, s[8:11], s31 offen sc1
  s_mov_b32 exec_hi, -1
  ds_read_b64_tr_b16 v[192:193], v242 offset:44032
  ds_read_b64_tr_b16 v[194:195], v242 offset:44544
  s_waitcnt lgkmcnt(6)
  v_mfma_f32_32x32x16_bf16 v[144:159], v[64:67], v[180:183], v[144:159]
  ds_read_b64_tr_b16 v[196:197], v242 offset:45056
  ds_read_b64_tr_b16 v[198:199], v242 offset:45568
  s_waitcnt lgkmcnt(6)
  v_mfma_f32_32x32x16_bf16 v[128:143], v[68:71], v[184:187], v[128:143]
  ds_read_b64_tr_b16 v[176:177], v242 offset:47104
  ds_read_b64_tr_b16 v[178:179], v242 offset:47616
  s_waitcnt lgkmcnt(6)
  v_mfma_f32_32x32x16_bf16 v[144:159], v[68:71], v[188:191], v[144:159]
  s_barrier
  ds_read_b64 v[80:81], v166 offset:4096
  ds_read_b64 v[82:83], v167 offset:4096
  ds_read_b64 v[84:85], v168 offset:4096
  ds_read_b64 v[86:87], v169 offset:4096
  ds_read_b64 v[88:89], v170 offset:4096
  ds_read_b64 v[90:91], v171 offset:4096
  ds_read_b64 v[92:93], v172 offset:4096
  ds_read_b64 v[94:95], v173 offset:4096
  ds_read_b64_tr_b16 v[228:229], v245 offset:50176
  ds_read_b64_tr_b16 v[230:231], v245 offset:50688
  ds_read_b64_tr_b16 v[236:237], v245 offset:51200
  ds_read_b64_tr_b16 v[238:239], v245 offset:51712
  ds_read_b64_tr_b16 v[180:181], v242 offset:48128
  ds_read_b64_tr_b16 v[182:183], v242 offset:48640
  s_waitcnt lgkmcnt(15)
  v_mfma_f32_32x32x16_bf16 v[128:143], v[72:75], v[192:195], v[128:143]
  ds_read_b64_tr_b16 v[184:185], v242 offset:50176
  ds_read_b64_tr_b16 v[186:187], v242 offset:50688
  v_mfma_f32_32x32x16_bf16 v[144:159], v[72:75], v[196:199], v[144:159]
  s_mul_i32 s24, s23, 172032
  s_add_u32 s24, s24, s22
  s_add_u32 m0, s15, 74752
  s_add_u32 s24, s24, 896
  buffer_load_dwordx4 v174, s[68:71], s24 offen lds
  s_add_u32 m0, s15, 75776
  s_add_u32 s24, s24, 896
  buffer_load_dwordx4 v174, s[68:71], s24 offen lds
  ds_read_b64_tr_b16 v[188:189], v242 offset:51200
  ds_read_b64_tr_b16 v[190:191], v242 offset:51712
  s_waitcnt lgkmcnt(15)
  v_mfma_f32_32x32x16_bf16 v[128:143], v[76:79], v[176:179], v[128:143]
  s_add_u32 m0, s21, 0
  s_lshl_b32 s24, s23, 7
  s_add_u32 s24, s24, s20
  buffer_load_dwordx4 v164, s[64:67], s24 offen offset:0 lds
  s_add_u32 s24, s24, 6144
  buffer_load_dwordx4 v165, s[64:67], s24 offen offset:1024 lds
  s_add_u32 s24, s24, 6144
  buffer_load_dwordx4 v164, s[64:67], s24 offen offset:2048 lds
  s_add_u32 s24, s24, 6144
  buffer_load_dwordx4 v165, s[64:67], s24 offen offset:3072 lds
  s_add_u32 s23, s23, 1
  s_cmp_eq_u32 s23, 7
  s_cselect_b32 s23, 0, s23
  ds_read_b64_tr_b16 v[192:193], v242 offset:53248
  ds_read_b64_tr_b16 v[194:195], v242 offset:53760
  s_waitcnt lgkmcnt(6)
  v_mfma_f32_32x32x16_bf16 v[144:159], v[76:79], v[180:183], v[144:159]
  ds_read_b64_tr_b16 v[196:197], v242 offset:54272
  ds_read_b64_tr_b16 v[198:199], v242 offset:54784
  v_dot2_f32_bf16 v160, v80, s19, v160
  v_dot2_f32_bf16 v161, v80, v80, v161
  v_dot2_f32_bf16 v160, v81, s19, v160
  v_dot2_f32_bf16 v161, v81, v81, v161
  v_dot2_f32_bf16 v160, v82, s19, v160
  v_dot2_f32_bf16 v161, v82, v82, v161
  v_dot2_f32_bf16 v160, v83, s19, v160
  v_dot2_f32_bf16 v161, v83, v83, v161
  v_dot2_f32_bf16 v160, v84, s19, v160
  v_dot2_f32_bf16 v161, v84, v84, v161
  v_dot2_f32_bf16 v160, v85, s19, v160
  v_dot2_f32_bf16 v161, v85, v85, v161
  v_dot2_f32_bf16 v160, v86, s19, v160
  v_dot2_f32_bf16 v161, v86, v86, v161
  v_dot2_f32_bf16 v160, v87, s19, v160
  v_dot2_f32_bf16 v161, v87, v87, v161
  v_dot2_f32_bf16 v160, v88, s19, v160
  v_dot2_f32_bf16 v161, v88, v88, v161
  v_dot2_f32_bf16 v160, v89, s19, v160
  v_dot2_f32_bf16 v161, v89, v89, v161
  v_dot2_f32_bf16 v160, v90, s19, v160
  v_dot2_f32_bf16 v161, v90, v90, v161
  v_dot2_f32_bf16 v160, v91, s19, v160
  v_dot2_f32_bf16 v161, v91, v91, v161
  v_dot2_f32_bf16 v160, v92, s19, v160
  v_dot2_f32_bf16 v161, v92, v92, v161
  v_dot2_f32_bf16 v160, v93, s19, v160
  v_dot2_f32_bf16 v161, v93, v93, v161
  v_dot2_f32_bf16 v160, v94, s19, v160
  v_dot2_f32_bf16 v161, v94, v94, v161
  v_dot2_f32_bf16 v160, v95, s19, v160
  v_dot2_f32_bf16 v161, v95, v95, v161
  v_dot2_f32_bf16 v247, v228, s19, v247
  v_dot2_f32_bf16 v248, v236, s19, v248
  v_dot2_f32_bf16 v247, v229, s19, v247
  v_dot2_f32_bf16 v248, v237, s19, v248
  v_dot2_f32_bf16 v247, v230, s19, v247
  v_dot2_f32_bf16 v248, v238, s19, v248
  v_dot2_f32_bf16 v247, v231, s19, v247
  v_dot2_f32_bf16 v248, v239, s19, v248
  s_waitcnt lgkmcnt(6)
  v_mfma_f32_32x32x16_bf16 v[128:143], v[80:83], v[184:187], v[128:143]
  s_mul_i32 s24, s23, 172032
  s_add_u32 s24, s24, s22
  s_add_u32 m0, s15, 0
  s_add_u32 s23, s23, 1
  s_cmp_eq_u32 s23, 7
  s_cselect_b32 s23, 0, s23
  buffer_load_dwordx4 v174, s[68:71], s24 offen lds
  ds_read_b64_tr_b16 v[176:177], v242 offset:56320
  ds_read_b64_tr_b16 v[178:179], v242 offset:56832
  s_waitcnt lgkmcnt(6)
  v_mfma_f32_32x32x16_bf16 v[144:159], v[80:83], v[188:191], v[144:159]
  s_mul_i32 s24, s23, 172032
  s_add_u32 s24, s24, s22
  s_add_u32 m0, s15, 12288
  s_add_u32 s23, s23, 1
  s_cmp_eq_u32 s23, 7
  s_cselect_b32 s23, 0, s23
  buffer_load_dwordx4 v174, s[68:71], s24 offen lds
  ds_read_b64_tr_b16 v[180:181], v242 offset:57344
  ds_read_b64_tr_b16 v[182:183], v242 offset:57856
  s_waitcnt lgkmcnt(6)
  v_mfma_f32_32x32x16_bf16 v[128:143], v[84:87], v[192:195], v[128:143]
  s_mul_i32 s24, s23, 172032
  s_add_u32 s24, s24, s22
  s_add_u32 m0, s15, 24576
  s_add_u32 s23, s23, 1
  s_cmp_eq_u32 s23, 7
  s_cselect_b32 s23, 0, s23
  buffer_load_dwordx4 v174, s[68:71], s24 offen lds
  ds_read_b64_tr_b16 v[184:185], v242 offset:59392
  ds_read_b64_tr_b16 v[186:187], v242 offset:59904
  s_waitcnt lgkmcnt(6)
  v_mfma_f32_32x32x16_bf16 v[144:159], v[84:87], v[196:199], v[144:159]
  s_waitcnt vmcnt(13)
  s_waitcnt vmcnt(9)
  s_barrier
  s_cmp_lg_u32 s4, 0
  s_cbranch_scc1 sig_6
  s_add_u32 s48, s62, 1
  v_mov_b32 v4, s48
  v_mov_b32 v6, 0
  s_mov_b64 exec, 1
  v_mov_b32 v5, s45
  buffer_store_dwordx2 v[4:5], v6, s[8:11], s46 offen sc1
  s_mov_b64 exec, -1
  s_nop 1
sig_6:
  s_add_u32 s62, s62, 1
  ds_read_b64 v[96:97], v166 offset:8192
  ds_read_b64 v[98:99], v167 offset:8192
  ds_read_b64 v[100:101], v168 offset:8192
  ds_read_b64 v[102:103], v169 offset:8192
  ds_read_b64 v[104:105], v170 offset:8192
  ds_read_b64 v[106:107], v171 offset:8192
  ds_read_b64 v[108:109], v172 offset:8192
  ds_read_b64 v[110:111], v173 offset:8192
  ds_read_b64_tr_b16 v[228:229], v245 offset:62464
  ds_read_b64_tr_b16 v[230:231], v245 offset:62976
  ds_read_b64_tr_b16 v[236:237], v245 offset:63488
  ds_read_b64_tr_b16 v[238:239], v245 offset:64000
  ds_read_b64_tr_b16 v[188:189], v242 offset:60416
  ds_read_b64_tr_b16 v[190:191], v242 offset:60928
  s_waitcnt lgkmcnt(15)
  v_mfma_f32_32x32x16_bf16 v[128:143], v[88:91], v[176:179], v[128:143]
  s_mul_i32 s24, s23, 172032
  s_add_u32 s24, s24, s22
  s_add_u32 m0, s15, 36864
  s_add_u32 s23, s23, 1
  s_cmp_eq_u32 s23, 7
  s_cselect_b32 s23, 0, s23
  buffer_load_dwordx4 v174, s[68:71], s24 offen lds
  ds_read_b64_tr_b16 v[192:193], v242 offset:62464
  ds_read_b64_tr_b16 v[194:195], v242 offset:62976
  v_mfma_f32_32x32x16_bf16 v[144:159], v[88:91], v[180:183], v[144:159]
  s_mul_i32 s24, s23, 172032
  s_add_u32 s24, s24, s22
  s_add_u32 m0, s15, 49152
  s_add_u32 s23, s23, 1
  s_cmp_eq_u32 s23, 7
  s_cselect_b32 s23, 0, s23
  buffer_load_dwordx4 v174, s[68:71], s24 offen lds
  ds_read_b64_tr_b16 v[196:197], v242 offset:63488
  ds_read_b64_tr_b16 v[198:199], v242 offset:64000
  s_waitcnt lgkmcnt(15)
  v_mfma_f32_32x32x16_bf16 v[128:143], v[92:95], v[184:187], v[128:143]
  s_mul_i32 s24, s23, 172032
  s_add_u32 s24, s24, s22
  s_add_u32 m0, s15, 61440
  s_add_u32 s23, s23, 1
  s_cmp_eq_u32 s23, 7
  s_cselect_b32 s23, 0, s23
  buffer_load_dwordx4 v174, s[68:71], s24 offen lds
  ds_read_b64_tr_b16 v[176:177], v243 offset:0
  ds_read_b64_tr_b16 v[178:179], v243 offset:512
  s_waitcnt lgkmcnt(6)
  v_mfma_f32_32x32x16_bf16 v[144:159], v[92:95], v[188:191], v[144:159]
  s_mul_i32 s24, s23, 172032
  s_add_u32 s24, s24, s22
  s_add_u32 m0, s15, 73728
  s_add_u32 s23, s23, 1
  s_cmp_eq_u32 s23, 7
  s_cselect_b32 s23, 0, s23
  buffer_load_dwordx4 v174, s[68:71], s24 offen lds
  s_add_u32 s87, s86, 2097152
  s_add_u32 s88, s84, 0
  s_add_u32 s89, s85, 1835008
  v_lshlrev_b32 v250, 1, v1
  buffer_load_dword v255, v250, s[8:11], s87 offen sc1
  buffer_load_dword v255, v250, s[8:11], s88 offen sc1
  s_mov_b64 exec, 0xff
  buffer_load_dword v255, v250, s[8:11], s89 offen sc1
  s_mov_b64 exec, -1
  ds_read_b64_tr_b16 v[180:181], v243 offset:1024
  ds_read_b64_tr_b16 v[182:183], v243 offset:1536
  s_waitcnt vmcnt(14)
  ds_read_b64_tr_b16 v[8:9], v246 offset:9216
  ds_read_b64_tr_b16 v[10:11], v246 offset:9728
  ds_read_b64_tr_b16 v[124:125], v246 offset:10240
  ds_read_b64_tr_b16 v[126:127], v246 offset:10752
  v_dot2_f32_bf16 v160, v96, s19, v160
  v_dot2_f32_bf16 v161, v96, v96, v161
  v_dot2_f32_bf16 v160, v97, s19, v160
  v_dot2_f32_bf16 v161, v97, v97, v161
  v_dot2_f32_bf16 v160, v98, s19, v160
  v_dot2_f32_bf16 v161, v98, v98, v161
  v_dot2_f32_bf16 v160, v99, s19, v160
  v_dot2_f32_bf16 v161, v99, v99, v161
  v_dot2_f32_bf16 v160, v100, s19, v160
  v_dot2_f32_bf16 v161, v100, v100, v161
  v_dot2_f32_bf16 v160, v101, s19, v160
  v_dot2_f32_bf16 v161, v101, v101, v161
  v_dot2_f32_bf16 v160, v102, s19, v160
  v_dot2_f32_bf16 v161, v102, v102, v161
  v_dot2_f32_bf16 v160, v103, s19, v160
  v_dot2_f32_bf16 v161, v103, v103, v161
  v_dot2_f32_bf16 v160, v104, s19, v160
  v_dot2_f32_bf16 v161, v104, v104, v161
  v_dot2_f32_bf16 v160, v105, s19, v160
  v_dot2_f32_bf16 v161, v105, v105, v161
  v_dot2_f32_bf16 v160, v106, s19, v160
  v_dot2_f32_bf16 v161, v106, v106, v161
  v_dot2_f32_bf16 v160, v107, s19, v160
  v_dot2_f32_bf16 v161, v107, v107, v161
  v_dot2_f32_bf16 v160, v108, s19, v160
  v_dot2_f32_bf16 v161, v108, v108, v161
  v_dot2_f32_bf16 v160, v109, s19, v160
  v_dot2_f32_bf16 v161, v109, v109, v161
  v_dot2_f32_bf16 v160, v110, s19, v160
  v_dot2_f32_bf16 v161, v110, v110, v161
  v_dot2_f32_bf16 v160, v111, s19, v160
  v_dot2_f32_bf16 v161, v111, v111, v161
  v_dot2_f32_bf16 v247, v228, s19, v247
  v_dot2_f32_bf16 v248, v236, s19, v248
  v_dot2_f32_bf16 v247, v229, s19, v247
  v_dot2_f32_bf16 v248, v237, s19, v248
  v_dot2_f32_bf16 v247, v230, s19, v247
  v_dot2_f32_bf16 v248, v238, s19, v248
  v_dot2_f32_bf16 v247, v231, s19, v247
  v_dot2_f32_bf16 v248, v239, s19, v248
  s_waitcnt lgkmcnt(3)
  v_dot2_f32_bf16 v247, v8, s19, v247
  s_waitcnt lgkmcnt(1)
  v_dot2_f32_bf16 v248, v124, s19, v248
  v_dot2_f32_bf16 v247, v9, s19, v247
  v_dot2_f32_bf16 v248, v125, s19, v248
  v_dot2_f32_bf16 v247, v10, s19, v247
  s_waitcnt lgkmcnt(0)
  v_dot2_f32_bf16 v248, v126, s19, v248
  v_dot2_f32_bf16 v247, v11, s19, v247
  v_dot2_f32_bf16 v248, v127, s19, v248
  s_nop 1
  v_mov_b32 v228, v247
  v_mov_b32 v229, v248
  s_nop 0
  v_permlane32_swap_b32 v247, v228
  v_permlane32_swap_b32 v248, v229
  v_add_f32 v247, v247, v228
  v_add_f32 v248, v248, v229
  s_lshl_b32 s12, s4, 8
  s_add_u32 s12, s12, 160256
  v_add_u32 v230, s12, v244
  ds_write2_b32 v230, v247, v248 offset0:0 offset1:32
  v_mfma_f32_32x32x16_bf16 v[128:143], v[96:99], v[192:195], v[128:143]
  s_lshr_b32 s24, s2, 3
  s_lshl_b32 s24, s24, 2
  s_add_u32 s24, s24, s4
  v_lshlrev_b32 v254, 3, v1
  s_mul_i32 s26, s24, 3200
  s_mov_b64 exec, 0x1ffffff
  buffer_load_dword v255, v254, s[76:79], s26 offen
  buffer_load_dword v255, v254, s[80:83], s26 offen
  s_mov_b64 exec, -1
  ds_read_b64_tr_b16 v[184:185], v243 offset:3072
  ds_read_b64_tr_b16 v[186:187], v243 offset:3584
  v_mfma_f32_32x32x16_bf16 v[144:159], v[96:99], v[196:199], v[144:159]
  ds_read_b64_tr_b16 v[188:189], v243 offset:4096
  ds_read_b64_tr_b16 v[190:191], v243 offset:4608
  v_mfma_f32_32x32x16_bf16 v[128:143], v[100:103], v[176:179], v[128:143]
  ds_read_b64_tr_b16 v[192:193], v243 offset:6144
  ds_read_b64_tr_b16 v[194:195], v243 offset:6656
  v_mfma_f32_32x32x16_bf16 v[144:159], v[100:103], v[180:183], v[144:159]
  s_waitcnt vmcnt(12)
  s_waitcnt lgkmcnt(6)
  s_barrier
  ds_read_b64 v[112:113], v166 offset:0
  ds_read_b64 v[114:115], v167 offset:0
  ds_read_b64 v[116:117], v168 offset:0
  ds_read_b64 v[118:119], v169 offset:0
  ds_read_b64 v[120:121], v170 offset:0
  ds_read_b64 v[122:123], v171 offset:0
  ds_read_b64 v[124:125], v172 offset:0
  ds_read_b64 v[126:127], v173 offset:0
  ds_read_b64_tr_b16 v[196:197], v243 offset:7168
  ds_read_b64_tr_b16 v[198:199], v243 offset:7680
  s_waitcnt lgkmcnt(14)
  v_mfma_f32_32x32x16_bf16 v[128:143], v[104:107], v[184:187], v[128:143]
  ds_read_b64_tr_b16 v[176:177], v243 offset:9216
  ds_read_b64_tr_b16 v[178:179], v243 offset:9728
  s_waitcnt lgkmcnt(14)
  v_mfma_f32_32x32x16_bf16 v[144:159], v[104:107], v[188:191], v[144:159]
  ds_read_b64_tr_b16 v[180:181], v243 offset:10240
  ds_read_b64_tr_b16 v[182:183], v243 offset:10752
  s_waitcnt lgkmcnt(14)
  v_mfma_f32_32x32x16_bf16 v[128:143], v[108:111], v[192:195], v[128:143]
  ds_read_b64_tr_b16 v[184:185], v243 offset:12288
  ds_read_b64_tr_b16 v[186:187], v243 offset:12800
  s_waitcnt lgkmcnt(6)
  v_mfma_f32_32x32x16_bf16 v[144:159], v[108:111], v[196:199], v[144:159]
  ds_read_b64_tr_b16 v[188:189], v243 offset:13312
  ds_read_b64_tr_b16 v[190:191], v243 offset:13824
  v_dot2_f32_bf16 v160, v112, s19, v160
  v_dot2_f32_bf16 v161, v112, v112, v161
  v_dot2_f32_bf16 v160, v113, s19, v160
  v_dot2_f32_bf16 v161, v113, v113, v161
  v_dot2_f32_bf16 v160, v114, s19, v160
  v_dot2_f32_bf16 v161, v114, v114, v161
  v_dot2_f32_bf16 v160, v115, s19, v160
  v_dot2_f32_bf16 v161, v115, v115, v161
  v_dot2_f32_bf16 v160, v116, s19, v160
  v_dot2_f32_bf16 v161, v116, v116, v161
  v_dot2_f32_bf16 v160, v117, s19, v160
  v_dot2_f32_bf16 v161, v117, v117, v161
  v_dot2_f32_bf16 v160, v118, s19, v160
  v_dot2_f32_bf16 v161, v118, v118, v161
  v_dot2_f32_bf16 v160, v119, s19, v160
  v_dot2_f32_bf16 v161, v119, v119, v161
  v_dot2_f32_bf16 v160, v120, s19, v160
  v_dot2_f32_bf16 v161, v120, v120, v161
  v_dot2_f32_bf16 v160, v121, s19, v160
  v_dot2_f32_bf16 v161, v121, v121, v161
  v_dot2_f32_bf16 v160, v122, s19, v160
  v_dot2_f32_bf16 v161, v122, v122, v161
  v_dot2_f32_bf16 v160, v123, s19, v160
  v_dot2_f32_bf16 v161, v123, v123, v161
  v_dot2_f32_bf16 v160, v124, s19, v160
  v_dot2_f32_bf16 v161, v124, v124, v161
  v_dot2_f32_bf16 v160, v125, s19, v160
  v_dot2_f32_bf16 v161, v125, v125, v161
  v_dot2_f32_bf16 v160, v126, s19, v160
  v_dot2_f32_bf16 v161, v126, v126, v161
  v_dot2_f32_bf16 v160, v127, s19, v160
  v_dot2_f32_bf16 v161, v127, v127, v161
  s_waitcnt lgkmcnt(6)
  v_mfma_f32_32x32x16_bf16 v[128:143], v[112:115], v[176:179], v[128:143]
  ds_read_b64_tr_b16 v[192:193], v243 offset:15360
  ds_read_b64_tr_b16 v[194:195], v243 offset:15872
  v_add_u32 v245, 160256, v244
  ds_read2_b32 v[216:217], v245 offset0:0 offset1:64
  ds_read2_b32 v[218:219], v245 offset0:128 offset1:192
  ds_read2_b32 v[220:221], v245 offset0:32 offset1:96
  s_waitcnt lgkmcnt(9)
  v_mfma_f32_32x32x16_bf16 v[144:159], v[112:115], v[180:183], v[144:159]
  ds_read_b64_tr_b16 v[196:197], v243 offset:16384
  ds_read_b64_tr_b16 v[198:199], v243 offset:16896
  ds_read2_b32 v[222:223], v245 offset0:160 offset1:224
  v_mov_b32 v162, v160
  v_mov_b32 v163, v161
  s_nop 0
  v_permlane32_swap_b32 v160, v162
  s_waitcnt lgkmcnt(10)
  v_mfma_f32_32x32x16_bf16 v[128:143], v[116:119], v[184:187], v[128:143]
  ds_read_b64_tr_b16 v[176:177], v243 offset:18432
  ds_read_b64_tr_b16 v[178:179], v243 offset:18944
  v_permlane32_swap_b32 v161, v163
  v_add_f32 v160, v160, v162
  v_add_f32 v161, v161, v163
  s_mov_b32 s16, 0x3b124925
  s_waitcnt lgkmcnt(10)
  v_mfma_f32_32x32x16_bf16 v[144:159], v[116:119], v[188:191], v[144:159]
  ds_read_b64_tr_b16 v[180:181], v243 offset:19456
  ds_read_b64_tr_b16 v[182:183], v243 offset:19968
  v_mul_f32 v160, s16, v160
  v_mul_f32 v161, s16, v161
  v_fma_f32 v161, -v160, v160, v161
  v_max_f32 v161, 0, v161
  s_waitcnt lgkmcnt(10)
  v_mfma_f32_32x32x16_bf16 v[128:143], v[120:123], v[192:195], v[128:143]
  v_add_f32 v161, 0x3727c5ac, v161
  v_rsq_f32 v232, v161
  v_sub_f32 v160, 0, v160
  ds_write_b32 v240, v232
  s_waitcnt lgkmcnt(6)
  v_mfma_f32_32x32x16_bf16 v[144:159], v[120:123], v[196:199], v[144:159]
  ds_read_b128 v[200:203], v241 offset:0
  ds_read_b128 v[204:207], v241 offset:32
  ds_read_b128 v[208:211], v241 offset:64
  ds_read_b128 v[212:215], v241 offset:96
  s_waitcnt lgkmcnt(7)
  v_mfma_f32_32x32x16_bf16 v[128:143], v[124:127], v[176:179], v[128:143]
  v_and_b32 v236, 0xffff0000, v160
  v_sub_f32 v237, v160, v236
  v_and_b32 v238, 0xffff0000, v237
  v_sub_f32 v239, v237, v238
  s_waitcnt lgkmcnt(5)
  v_mfma_f32_32x32x16_bf16 v[144:159], v[124:127], v[180:183], v[144:159]
  v_perm_b32 v228, v236, v236, s17
  v_perm_b32 v229, v238, v236, s17
  v_perm_b32 v230, v239, v238, s17
  v_mov_b32 v231, 0
  v_mul_f32 v234, 0x3fb8aa3b, v232
  v_add_f32 v216, v216, v217
  v_add_f32 v218, v218, v219
  v_add_f32 v9, v216, v218
  v_add_f32 v220, v220, v221
  v_add_f32 v222, v222, v223
  v_add_f32 v10, v220, v222
  v_cmp_eq_u32 s[56:57], 0, v3
  s_nop 1
  v_cndmask_b32 v236, 0, v9, s[56:57]
  v_and_b32 v237, 0xffff0000, v236
  v_sub_f32 v236, v236, v237
  v_and_b32 v238, 0xffff0000, v236
  v_sub_f32 v239, v236, v238
  v_perm_b32 v220, v238, v237, s17
  v_perm_b32 v221, v237, v239, s17
  v_perm_b32 v222, v237, v238, s17
  v_mov_b32 v223, 0
  v_cndmask_b32 v236, 0, v10, s[56:57]
  v_and_b32 v237, 0xffff0000, v236
  v_sub_f32 v236, v236, v237
  v_and_b32 v238, 0xffff0000, v236
  v_sub_f32 v239, v236, v238
  v_perm_b32 v224, v238, v237, s17
  v_perm_b32 v225, v237, v239, s17
  v_perm_b32 v226, v237, v238, s17
  v_mov_b32 v227, 0
  v_mfma_f32_32x32x16_bf16 v[128:143], v[228:231], v[220:223], v[128:143]
  s_nop 0
  v_mfma_f32_32x32x16_bf16 v[144:159], v[228:231], v[224:227], v[144:159]
  v_mov_b32 v253, v244
  s_mov_b32 s16, 0x358637bd
  s_mov_b32 s17, 0x358637bd
  s_mov_b32 s18, 0x3fb8aa3b
  s_lshl_b32 s19, s4, 12
  s_add_u32 s19, s19, 143360
  v_add_u32 v240, s19, v1
  v_lshlrev_b32 v239, 2, v0
  v_add_u32 v241, 143360, v239
  v_mov_b32 v236, 1.0
  s_waitcnt lgkmcnt(3)
  v_pk_mul_f32 v[128:129], v[128:129], v[200:201]
  v_pk_mul_f32 v[244:245], v[128:129], s[18:19] op_sel_hi:[1,0]
  v_pk_add_f32 v[128:129], v[128:129], 1.0 op_sel_hi:[1,0]
  v_exp_f32 v244, v244
  v_exp_f32 v245, v245
  v_med3_f32 v128, v244, v128, 1.0
  v_med3_f32 v129, v245, v129, 1.0
  v_pk_add_f32 v[128:129], v[128:129], s[16:17]
  v_cvt_pk_bf16_f32 v128, v128, v129
  v_pk_mul_f32 v[130:131], v[130:131], v[202:203]
  v_pk_mul_f32 v[246:247], v[130:131], s[18:19] op_sel_hi:[1,0]
  v_pk_add_f32 v[130:131], v[130:131], 1.0 op_sel_hi:[1,0]
  v_exp_f32 v246, v246
  v_exp_f32 v247, v247
  v_med3_f32 v130, v246, v130, 1.0
  v_med3_f32 v131, v247, v131, 1.0
  v_pk_add_f32 v[130:131], v[130:131], s[16:17]
  v_cvt_pk_bf16_f32 v129, v130, v131
  s_waitcnt lgkmcnt(2)
  v_pk_mul_f32 v[132:133], v[132:133], v[204:205]
  v_pk_mul_f32 v[248:249], v[132:133], s[18:19] op_sel_hi:[1,0]
  v_pk_add_f32 v[132:133], v[132:133], 1.0 op_sel_hi:[1,0]
  v_exp_f32 v248, v248
  v_exp_f32 v249, v249
  v_med3_f32 v132, v248, v132, 1.0
  v_med3_f32 v133, v249, v133, 1.0
  v_pk_add_f32 v[132:133], v[132:133], s[16:17]
  v_cvt_pk_bf16_f32 v130, v132, v133
  v_pk_mul_f32 v[134:135], v[134:135], v[206:207]
  v_pk_mul_f32 v[244:245], v[134:135], s[18:19] op_sel_hi:[1,0]
  v_pk_add_f32 v[134:135], v[134:135], 1.0 op_sel_hi:[1,0]
  v_exp_f32 v244, v244
  v_exp_f32 v245, v245
  v_med3_f32 v134, v244, v134, 1.0
  v_med3_f32 v135, v245, v135, 1.0
  v_pk_add_f32 v[134:135], v[134:135], s[16:17]
  v_cvt_pk_bf16_f32 v131, v134, v135
  s_waitcnt lgkmcnt(1)
  v_pk_mul_f32 v[136:137], v[136:137], v[208:209]
  v_pk_mul_f32 v[246:247], v[136:137], s[18:19] op_sel_hi:[1,0]
  v_pk_add_f32 v[136:137], v[136:137], 1.0 op_sel_hi:[1,0]
  v_exp_f32 v246, v246
  v_exp_f32 v247, v247
  v_med3_f32 v136, v246, v136, 1.0
  v_med3_f32 v137, v247, v137, 1.0
  v_pk_add_f32 v[136:137], v[136:137], s[16:17]
  v_cvt_pk_bf16_f32 v132, v136, v137
  v_pk_mul_f32 v[138:139], v[138:139], v[210:211]
  v_pk_mul_f32 v[248:249], v[138:139], s[18:19] op_sel_hi:[1,0]
  v_pk_add_f32 v[138:139], v[138:139], 1.0 op_sel_hi:[1,0]
  v_exp_f32 v248, v248
  v_exp_f32 v249, v249
  v_med3_f32 v138, v248, v138, 1.0
  v_med3_f32 v139, v249, v139, 1.0
  v_pk_add_f32 v[138:139], v[138:139], s[16:17]
  v_cvt_pk_bf16_f32 v133, v138, v139
  s_waitcnt lgkmcnt(0)
  v_pk_mul_f32 v[140:141], v[140:141], v[212:213]
  v_pk_mul_f32 v[244:245], v[140:141], s[18:19] op_sel_hi:[1,0]
  v_pk_add_f32 v[140:141], v[140:141], 1.0 op_sel_hi:[1,0]
  v_exp_f32 v244, v244
  v_exp_f32 v245, v245
  v_med3_f32 v140, v244, v140, 1.0
  v_med3_f32 v141, v245, v141, 1.0
  v_pk_add_f32 v[140:141], v[140:141], s[16:17]
  v_cvt_pk_bf16_f32 v134, v140, v141
  v_pk_mul_f32 v[142:143], v[142:143], v[214:215]
  v_pk_mul_f32 v[246:247], v[142:143], s[18:19] op_sel_hi:[1,0]
  v_pk_add_f32 v[142:143], v[142:143], 1.0 op_sel_hi:[1,0]
  v_exp_f32 v246, v246
  v_exp_f32 v247, v247
  v_med3_f32 v142, v246, v142, 1.0
  v_med3_f32 v143, v247, v143, 1.0
  v_pk_add_f32 v[142:143], v[142:143], s[16:17]
  v_cvt_pk_bf16_f32 v135, v142, v143
  s_waitcnt vmcnt(5)
  s_barrier
  ds_read_b64_tr_b16 v[184:185], v242 offset:0
  ds_read_b64_tr_b16 v[186:187], v242 offset:512
  ds_read_b64_tr_b16 v[188:189], v242 offset:3072
  ds_read_b64_tr_b16 v[190:191], v242 offset:3584
  ds_read_b64_tr_b16 v[192:193], v242 offset:6144
  ds_read_b64_tr_b16 v[194:195], v242 offset:6656
  ds_read_b64_tr_b16 v[196:197], v242 offset:9216
  ds_read_b64_tr_b16 v[198:199], v242 offset:9728
  ds_read_b64_tr_b16 v[176:177], v242 offset:12288
  ds_read_b64_tr_b16 v[178:179], v242 offset:12800
  v_pk_mul_f32 v[144:145], v[144:145], v[200:201]
  v_cvt_pk_bf16_f32 v136, v144, v145
  v_pk_mul_f32 v[146:147], v[146:147], v[202:203]
  v_cvt_pk_bf16_f32 v137, v146, v147
  v_pk_mul_f32 v[148:149], v[148:149], v[204:205]
  v_cvt_pk_bf16_f32 v138, v148, v149
  v_pk_mul_f32 v[150:151], v[150:151], v[206:207]
  v_cvt_pk_bf16_f32 v139, v150, v151
  v_pk_mul_f32 v[152:153], v[152:153], v[208:209]
  v_cvt_pk_bf16_f32 v140, v152, v153
  v_pk_mul_f32 v[154:155], v[154:155], v[210:211]
  v_cvt_pk_bf16_f32 v141, v154, v155
  v_pk_mul_f32 v[156:157], v[156:157], v[212:213]
  v_cvt_pk_bf16_f32 v142, v156, v157
  v_pk_mul_f32 v[158:159], v[158:159], v[214:215]
  v_cvt_pk_bf16_f32 v143, v158, v159
  s_mov_b32 exec_lo, 0xf0000000
  s_mov_b32 exec_hi, 0xf0000000
  v_mov_b32 v136, v15
  v_mov_b32 v137, v15
  v_mov_b32 v138, v15
  v_mov_b32 v139, v15
  v_mov_b32 v140, v15
  v_mov_b32 v141, v15
  v_mov_b32 v142, v15
  v_mov_b32 v143, v15
  s_mov_b64 exec, -1
  v_mfma_f32_32x32x16_bf16 v[144:159], v[128:131], v[136:139], 0
  v_mfma_f32_32x32x16_bf16 v[144:159], v[132:135], v[140:143], v[144:159]
  s_lshl_b32 s22, s41, 12
  s_add_u32 s22, s22, 15335424
  s_cmp_ge_u32 s4, 2
  s_cselect_b32 s23, 1073741824, s22
  s_lshl_b32 s12, s7, 15
  s_lshl_b32 s13, s41, 11
  s_add_u32 s12, s12, s13
  s_add_u32 s12, s12, 2097152
  s_mul_i32 s61, s4, 21504
  s_mul_i32 s60, s41, 86016
  s_add_u32 s60, s60, s61
  s_add_u32 s60, s60, 13959168
  s_waitcnt lgkmcnt(8)
  v_mfma_f32_32x32x16_bf16 v[160:175], v[184:187], v[16:19], 0
  ds_read_b64_tr_b16 v[180:181], v242 offset:15360
  ds_read_b64_tr_b16 v[182:183], v242 offset:15872
  v_lshrrev_b32 v5, 4, v1
  v_lshrrev_b32 v4, 1, v5
  v_and_b32 v5, 1, v5
  v_lshl_add_u32 v4, v5, 3, v4
  s_lshl_b32 s48, s50, 4
  v_add_u32 v4, s48, v4
  v_lshlrev_b32 v4, 7, v4
  v_add_u32 v4, 15466496, v4
  s_and_b32 s48, s2, 7
  s_lshl_b32 s48, s48, 7
  s_add_u32 s48, s48, 15466500
  v_lshl_add_u32 v5, v2, 10, s48
  v_cmp_eq_u32 vcc, 1, v3
  s_nop 1
  v_cndmask_b32 v4, v4, v5, vcc
  buffer_load_dword v6, v4, s[8:11], 0 offen sc1
  s_mul_i32 s28, s41, 86016
  s_add_u32 s28, s28, s15
  s_add_u32 s28, s28, 12582912
  s_mul_i32 s29, s41, 384
  s_add_u32 s29, s29, 15532032
  s_waitcnt lgkmcnt(8)
  v_mfma_f32_32x32x16_bf16 v[160:175], v[188:191], v[20:23], v[160:175]
  ds_read_b64_tr_b16 v[184:185], v242 offset:18432
  ds_read_b64_tr_b16 v[186:187], v242 offset:18944
  ds_write_b128 v240, v[144:147] offset:0
  s_waitcnt lgkmcnt(9)
  v_mfma_f32_32x32x16_bf16 v[160:175], v[192:195], v[24:27], v[160:175]
  ds_read_b64_tr_b16 v[188:189], v242 offset:21504
  ds_read_b64_tr_b16 v[190:191], v242 offset:22016
  ds_write_b128 v240, v[148:151] offset:1024
  s_waitcnt lgkmcnt(10)
  v_mfma_f32_32x32x16_bf16 v[160:175], v[196:199], v[28:31], v[160:175]
  ds_read_b64_tr_b16 v[192:193], v242 offset:24576
  ds_read_b64_tr_b16 v[194:195], v242 offset:25088
  ds_write_b128 v240, v[152:155] offset:2048
  s_waitcnt lgkmcnt(11)
  v_mfma_f32_32x32x16_bf16 v[160:175], v[176:179], v[32:35], v[160:175]
  ds_read_b64_tr_b16 v[196:197], v242 offset:27648
  ds_read_b64_tr_b16 v[198:199], v242 offset:28160
  ds_write_b128 v240, v[156:159] offset:3072
  s_waitcnt lgkmcnt(12)
  v_mfma_f32_32x32x16_bf16 v[160:175], v[180:183], v[36:39], v[160:175]
  ds_read_b64_tr_b16 v[176:177], v242 offset:30720
  ds_read_b64_tr_b16 v[178:179], v242 offset:31232
  s_waitcnt lgkmcnt(12)
  v_mfma_f32_32x32x16_bf16 v[160:175], v[184:187], v[40:43], v[160:175]
  ds_read_b64_tr_b16 v[180:181], v242 offset:33792
  ds_read_b64_tr_b16 v[182:183], v242 offset:34304
  s_waitcnt lgkmcnt(4)
  s_barrier
  ds_read2st64_b32 v[200:201], v241 offset0:0 offset1:16
  ds_read2st64_b32 v[202:203], v241 offset0:32 offset1:48
  ds_read2st64_b32 v[204:205], v241 offset0:4 offset1:20
  ds_read2st64_b32 v[206:207], v241 offset0:36 offset1:52
  ds_read2st64_b32 v[208:209], v241 offset0:8 offset1:24
  ds_read2st64_b32 v[210:211], v241 offset0:40 offset1:56
  ds_read2st64_b32 v[212:213], v241 offset0:12 offset1:28
  ds_read2st64_b32 v[214:215], v241 offset0:44 offset1:60
  v_mfma_f32_32x32x16_bf16 v[160:175], v[188:191], v[44:47], v[160:175]
  ds_read_b64_tr_b16 v[184:185], v242 offset:36864
  ds_read_b64_tr_b16 v[186:187], v242 offset:37376
  v_mfma_f32_32x32x16_bf16 v[160:175], v[192:195], v[48:51], v[160:175]
  ds_read_b64_tr_b16 v[188:189], v242 offset:39936
  ds_read_b64_tr_b16 v[190:191], v242 offset:40448
  v_mfma_f32_32x32x16_bf16 v[160:175], v[196:199], v[52:55], v[160:175]
  ds_read_b64_tr_b16 v[192:193], v242 offset:43008
  ds_read_b64_tr_b16 v[194:195], v242 offset:43520
  s_waitcnt lgkmcnt(13)
  v_add_f32 v200, v200, v201
  s_waitcnt lgkmcnt(12)
  v_add_f32 v202, v202, v203
  v_add_f32 v200, v200, v202
  buffer_atomic_add_f32 v200, v239, s[8:11], s22 offen offset:0 sc1
  s_waitcnt lgkmcnt(11)
  v_add_f32 v204, v204, v205
  s_waitcnt lgkmcnt(10)
  v_add_f32 v206, v206, v207
  v_add_f32 v204, v204, v206
  buffer_atomic_add_f32 v204, v239, s[8:11], s22 offen offset:1024 sc1
  v_mfma_f32_32x32x16_bf16 v[160:175], v[176:179], v[56:59], v[160:175]
  ds_read_b64_tr_b16 v[196:197], v242 offset:46080
  ds_read_b64_tr_b16 v[198:199], v242 offset:46592
  s_waitcnt lgkmcnt(11)
  v_add_f32 v208, v208, v209
  s_waitcnt lgkmcnt(10)
  v_add_f32 v210, v210, v211
  v_add_f32 v208, v208, v210
  buffer_atomic_add_f32 v208, v239, s[8:11], s22 offen offset:2048 sc1
  s_waitcnt lgkmcnt(9)
  v_add_f32 v212, v212, v213
  s_waitcnt lgkmcnt(8)
  v_add_f32 v214, v214, v215
  v_add_f32 v212, v212, v214
  buffer_atomic_add_f32 v212, v239, s[8:11], s23 offen offset:3072 sc1
  v_mfma_f32_32x32x16_bf16 v[160:175], v[180:183], v[60:63], v[160:175]
  ds_read_b64_tr_b16 v[176:177], v242 offset:49152
  ds_read_b64_tr_b16 v[178:179], v242 offset:49664
  s_waitcnt vmcnt(4)
  v_cmp_le_u32 vcc, s62, v6
  s_mov_b32 s58, 65535
  s_mov_b32 s59, -1
  s_and_b64 vcc, vcc, s[58:59]
  s_cmp_eq_u64 vcc, s[58:59]
  s_cbranch_scc1 look_7
  s_mov_b64 exec, s[58:59]
  s_mov_b32 s48, 400000
  s_waitcnt lgkmcnt(0)
poll_8:
  buffer_load_dword v6, v4, s[8:11], 0 offen sc1
  s_sub_u32 s48, s48, 1
  s_cbranch_scc1 k_end
  s_waitcnt vmcnt(0)
  v_cmp_le_u32 vcc, s62, v6
  s_nop 0
  s_cmp_eq_u64 vcc, exec
  s_cbranch_scc0 poll_8
  s_mov_b64 exec, -1
look_7:
  buffer_load_dword v8, v253, s[8:11], s29 offen offset:0 sc1
  buffer_load_dword v9, v253, s[8:11], s29 offen offset:128 sc1
  buffer_load_dword v10, v253, s[8:11], s29 offen offset:256 sc1
  s_add_u32 s29, s29, 6144
  buffer_load_dword v11, v253, s[8:11], s29 offen offset:0 sc1
  buffer_load_dword v12, v253, s[8:11], s29 offen offset:128 sc1
  buffer_load_dword v13, v253, s[8:11], s29 offen offset:256 sc1
  v_cmp_eq_u32 vcc, s45, v6
  s_nop 0
  s_cmp_eq_u32 vcc_hi, -1
  s_cselect_b32 s44, 1, 0
  v_lshrrev_b32 v251, 7, v1
  v_mul_u32_u24 v251, 896, v251
  v_lshrrev_b32 v252, 2, v1
  v_and_b32 v252, 64, v252
  v_xor_b32 v252, v252, v1
  v_and_b32 v252, 0x70, v252
  s_min_u32 s48, s43, 6
  s_lshl_b32 s48, s48, 7
  v_add3_u32 v251, v251, v252, s48
  s_mul_i32 s26, s4, 100352
  s_mul_i32 s27, s4, 14336
  s_waitcnt lgkmcnt(8)
  v_mfma_f32_32x32x16_bf16 v[160:175], v[184:187], v[64:67], v[160:175]
  ds_read_b64_tr_b16 v[180:181], v242 offset:52224
  ds_read_b64_tr_b16 v[182:183], v242 offset:52736
  s_add_u32 m0, s27, 86016
  s_add_u32 s25, s26, 0
  buffer_load_dwordx4 v251, s[76:79], s25 offen lds
  s_add_u32 m0, s27, 87040
  s_add_u32 s25, s26, 7168
  buffer_load_dwordx4 v251, s[76:79], s25 offen lds
  s_waitcnt lgkmcnt(8)
  v_mfma_f32_32x32x16_bf16 v[160:175], v[188:191], v[68:71], v[160:175]
  ds_read_b64_tr_b16 v[184:185], v242 offset:55296
  ds_read_b64_tr_b16 v[186:187], v242 offset:55808
  s_add_u32 m0, s27, 88064
  s_add_u32 s25, s26, 14336
  buffer_load_dwordx4 v251, s[76:79], s25 offen lds
  s_add_u32 m0, s27, 89088
  s_add_u32 s25, s26, 21504
  buffer_load_dwordx4 v251, s[76:79], s25 offen lds
  s_waitcnt lgkmcnt(8)
  v_mfma_f32_32x32x16_bf16 v[160:175], v[192:195], v[72:75], v[160:175]
  ds_read_b64_tr_b16 v[188:189], v242 offset:58368
  ds_read_b64_tr_b16 v[190:191], v242 offset:58880
  s_add_u32 m0, s27, 90112
  s_add_u32 s25, s26, 28672
  buffer_load_dwordx4 v251, s[76:79], s25 offen lds
  s_add_u32 m0, s27, 91136
  s_add_u32 s25, s26, 35840
  buffer_load_dwordx4 v251, s[76:79], s25 offen lds
  s_waitcnt lgkmcnt(8)
  v_mfma_f32_32x32x16_bf16 v[160:175], v[196:199], v[76:79], v[160:175]
  ds_read_b64_tr_b16 v[192:193], v242 offset:61440
  ds_read_b64_tr_b16 v[194:195], v242 offset:61952
  s_add_u32 m0, s27, 92160
  s_add_u32 s25, s26, 43008
  buffer_load_dwordx4 v251, s[76:79], s25 offen lds
  s_add_u32 m0, s27, 93184
  s_add_u32 s25, s26, 50176
  buffer_load_dwordx4 v251, s[76:79], s25 offen lds
  s_waitcnt lgkmcnt(8)
  v_mfma_f32_32x32x16_bf16 v[160:175], v[176:179], v[80:83], v[160:175]
  ds_read_b64_tr_b16 v[196:197], v242 offset:64512
  ds_read_b64_tr_b16 v[198:199], v242 offset:65024
  s_add_u32 m0, s27, 94208
  s_add_u32 s25, s26, 57344
  buffer_load_dwordx4 v251, s[76:79], s25 offen lds
  s_add_u32 m0, s27, 95232
  s_add_u32 s25, s26, 64512
  buffer_load_dwordx4 v251, s[76:79], s25 offen lds
  s_waitcnt lgkmcnt(8)
  v_mfma_f32_32x32x16_bf16 v[160:175], v[180:183], v[84:87], v[160:175]
  ds_read_b64_tr_b16 v[176:177], v243 offset:2048
  ds_read_b64_tr_b16 v[178:179], v243 offset:2560
  s_add_u32 m0, s27, 96256
  s_add_u32 s25, s26, 71680
  buffer_load_dwordx4 v251, s[76:79], s25 offen lds
  s_add_u32 m0, s27, 97280
  s_add_u32 s25, s26, 78848
  buffer_load_dwordx4 v251, s[76:79], s25 offen lds
  s_waitcnt lgkmcnt(8)
  v_mfma_f32_32x32x16_bf16 v[160:175], v[184:187], v[88:91], v[160:175]
  ds_read_b64_tr_b16 v[180:181], v243 offset:5120
  ds_read_b64_tr_b16 v[182:183], v243 offset:5632
  s_add_u32 m0, s27, 98304
  s_add_u32 s25, s26, 86016
  buffer_load_dwordx4 v251, s[76:79], s25 offen lds
  s_add_u32 m0, s27, 99328
  s_add_u32 s25, s26, 93184
  buffer_load_dwordx4 v251, s[76:79], s25 offen lds
  s_waitcnt lgkmcnt(8)
  v_mfma_f32_32x32x16_bf16 v[160:175], v[188:191], v[92:95], v[160:175]
  ds_read_b64_tr_b16 v[184:185], v243 offset:8192
  ds_read_b64_tr_b16 v[186:187], v243 offset:8704
  v_bfe_u32 v252, v1, 6, 2
  v_lshl_add_u32 v252, v3, 2, v252
  v_lshlrev_b32 v252, 7, v252
  v_bfe_u32 v253, v1, 7, 1
  s_and_b32 s49, s4, 1
  v_xor_b32 v253, s49, v253
  v_lshl_add_u32 v252, v253, 6, v252
  v_bfe_u32 v253, v1, 8, 1
  v_lshl_add_u32 v252, v253, 5, v252
  v_bfe_u32 v253, v1, 4, 2
  v_lshl_add_u32 v252, v253, 3, v252
  v_add_u32 v252, 86016, v252
  s_waitcnt lgkmcnt(8)
  v_mfma_f32_32x32x16_bf16 v[160:175], v[192:195], v[96:99], v[160:175]
  ds_read_b64_tr_b16 v[188:189], v243 offset:11264
  ds_read_b64_tr_b16 v[190:191], v243 offset:11776
  s_waitcnt lgkmcnt(8)
  v_mfma_f32_32x32x16_bf16 v[160:175], v[196:199], v[100:103], v[160:175]
  ds_read_b64_tr_b16 v[192:193], v243 offset:14336
  ds_read_b64_tr_b16 v[194:195], v243 offset:14848
  s_waitcnt lgkmcnt(8)
  v_mfma_f32_32x32x16_bf16 v[160:175], v[176:179], v[104:107], v[160:175]
  ds_read_b64_tr_b16 v[196:197], v243 offset:17408
  ds_read_b64_tr_b16 v[198:199], v243 offset:17920
  s_waitcnt lgkmcnt(8)
  v_mfma_f32_32x32x16_bf16 v[160:175], v[180:183], v[108:111], v[160:175]
  s_waitcnt lgkmcnt(6)
  v_mfma_f32_32x32x16_bf16 v[160:175], v[184:187], v[112:115], v[160:175]
  s_waitcnt lgkmcnt(4)
  v_mfma_f32_32x32x16_bf16 v[160:175], v[188:191], v[116:119], v[160:175]
  s_waitcnt lgkmcnt(2)
  v_mfma_f32_32x32x16_bf16 v[160:175], v[192:195], v[120:123], v[160:175]
  s_waitcnt lgkmcnt(0)
  v_mfma_f32_32x32x16_bf16 v[160:175], v[196:199], v[124:127], v[160:175]
  s_mov_b32 s17, 0x07060302
  v_cmp_eq_u32 s[56:57], 0, v3
  s_waitcnt vmcnt(19)
  s_nop 0
  v_cndmask_b32 v244, 0, v8, s[56:57]
  v_and_b32 v245, 0xffff0000, v244
  v_sub_f32 v244, v244, v245
  v_and_b32 v246, 0xffff0000, v244
  v_sub_f32 v247, v244, v246
  v_perm_b32 v216, v246, v245, s17
  v_perm_b32 v217, v245, v247, s17
  v_perm_b32 v218, v245, v246, s17
  v_mov_b32 v219, 0
  s_mov_b32 s17, 0x358637bd
  s_nop 0
  v_mfma_f32_32x32x16_bf16 v[160:175], v[216:219], v[228:231], v[160:175]
  s_barrier
  s_cmp_lg_u32 s4, 0
  s_cbranch_scc1 sig_9
  s_add_u32 s48, s62, 1
  v_mov_b32 v244, s48
  v_mov_b32 v246, 0
  s_mov_b64 exec, 1
  buffer_store_dword v244, v246, s[8:11], s46 offen sc1
  s_mov_b64 exec, -1
  s_nop 1
sig_9:
  s_add_u32 s62, s62, 1
  s_add_u32 m0, s61, 0
  s_add_u32 s59, s60, 0
  buffer_load_dwordx4 v1, s[8:11], s59 offen offset:1024 sc1 lds
  buffer_load_dwordx4 v1, s[8:11], s59 offen offset:2048 sc1 lds
  s_add_u32 m0, s61, 3072
  s_add_u32 s59, s60, 3072
  buffer_load_dwordx4 v1, s[8:11], s59 offen offset:1024 sc1 lds
  buffer_load_dwordx4 v1, s[8:11], s59 offen offset:2048 sc1 lds
  s_add_u32 m0, s61, 6144
  s_add_u32 s59, s60, 6144
  buffer_load_dwordx4 v1, s[8:11], s59 offen offset:1024 sc1 lds
  buffer_load_dwordx4 v1, s[8:11], s59 offen offset:2048 sc1 lds
  s_add_u32 m0, s61, 9216
  s_add_u32 s59, s60, 9216
  buffer_load_dwordx4 v1, s[8:11], s59 offen offset:1024 sc1 lds
  buffer_load_dwordx4 v1, s[8:11], s59 offen offset:2048 sc1 lds
  s_add_u32 m0, s61, 12288
  s_add_u32 s59, s60, 12288
  buffer_load_dwordx4 v1, s[8:11], s59 offen offset:1024 sc1 lds
  buffer_load_dwordx4 v1, s[8:11], s59 offen offset:2048 sc1 lds
  v_pk_mul_f32 v[244:245], v[160:161], v[234:235] op_sel_hi:[1,0]
  v_pk_fma_f32 v[160:161], v[160:161], v[232:233], v[236:237] op_sel_hi:[1,0,0]
  v_exp_f32 v244, v244
  v_exp_f32 v245, v245
  v_med3_f32 v160, v244, v160, 1.0
  v_med3_f32 v161, v245, v161, 1.0
  v_pk_add_f32 v[160:161], v[160:161], s[16:17]
  v_cvt_pk_bf16_f32 v16, v160, v161
  v_pk_mul_f32 v[246:247], v[162:163], v[234:235] op_sel_hi:[1,0]
  v_pk_fma_f32 v[162:163], v[162:163], v[232:233], v[236:237] op_sel_hi:[1,0,0]
  v_exp_f32 v246, v246
  v_exp_f32 v247, v247
  v_med3_f32 v162, v246, v162, 1.0
  v_med3_f32 v163, v247, v163, 1.0
  v_pk_add_f32 v[162:163], v[162:163], s[16:17]
  v_cvt_pk_bf16_f32 v17, v162, v163
  v_pk_mul_f32 v[248:249], v[164:165], v[234:235] op_sel_hi:[1,0]
  v_pk_fma_f32 v[164:165], v[164:165], v[232:233], v[236:237] op_sel_hi:[1,0,0]
  v_exp_f32 v248, v248
  v_exp_f32 v249, v249
  v_med3_f32 v164, v248, v164, 1.0
  v_med3_f32 v165, v249, v165, 1.0
  v_pk_add_f32 v[164:165], v[164:165], s[16:17]
  v_cvt_pk_bf16_f32 v18, v164, v165
  v_pk_mul_f32 v[244:245], v[166:167], v[234:235] op_sel_hi:[1,0]
  v_pk_fma_f32 v[166:167], v[166:167], v[232:233], v[236:237] op_sel_hi:[1,0,0]
  v_exp_f32 v244, v244
  v_exp_f32 v245, v245
  v_med3_f32 v166, v244, v166, 1.0
  v_med3_f32 v167, v245, v167, 1.0
  v_pk_add_f32 v[166:167], v[166:167], s[16:17]
  v_cvt_pk_bf16_f32 v19, v166, v167
  v_pk_mul_f32 v[246:247], v[168:169], v[234:235] op_sel_hi:[1,0]
  v_pk_fma_f32 v[168:169], v[168:169], v[232:233], v[236:237] op_sel_hi:[1,0,0]
  v_exp_f32 v246, v246
  v_exp_f32 v247, v247
  v_med3_f32 v168, v246, v168, 1.0
  v_med3_f32 v169, v247, v169, 1.0
  v_pk_add_f32 v[168:169], v[168:169], s[16:17]
  v_cvt_pk_bf16_f32 v20, v168, v169
  v_pk_mul_f32 v[248:249], v[170:171], v[234:235] op_sel_hi:[1,0]
  v_pk_fma_f32 v[170:171], v[170:171], v[232:233], v[236:237] op_sel_hi:[1,0,0]
  v_exp_f32 v248, v248
  v_exp_f32 v249, v249
  v_med3_f32 v170, v248, v170, 1.0
  v_med3_f32 v171, v249, v171, 1.0
  v_pk_add_f32 v[170:171], v[170:171], s[16:17]
  v_cvt_pk_bf16_f32 v21, v170, v171
  v_pk_mul_f32 v[244:245], v[172:173], v[234:235] op_sel_hi:[1,0]
  v_pk_fma_f32 v[172:173], v[172:173], v[232:233], v[236:237] op_sel_hi:[1,0,0]
  v_exp_f32 v244, v244
  v_exp_f32 v245, v245
  v_med3_f32 v172, v244, v172, 1.0
  v_med3_f32 v173, v245, v173, 1.0
  v_pk_add_f32 v[172:173], v[172:173], s[16:17]
  v_cvt_pk_bf16_f32 v22, v172, v173
  v_pk_mul_f32 v[246:247], v[174:175], v[234:235] op_sel_hi:[1,0]
  v_pk_fma_f32 v[174:175], v[174:175], v[232:233], v[236:237] op_sel_hi:[1,0,0]
  v_exp_f32 v246, v246
  v_exp_f32 v247, v247
  v_med3_f32 v174, v246, v174, 1.0
  v_med3_f32 v175, v247, v175, 1.0
  v_pk_add_f32 v[174:175], v[174:175], s[16:17]
  v_cvt_pk_bf16_f32 v23, v174, v175
  s_mov_b32 exec_lo, 0
  v_mov_b32 v22, 0
  v_mov_b32 v23, 0
  s_mov_b32 exec_lo, -1
  s_waitcnt vmcnt(10)
  s_barrier
  ds_read_b64_tr_b16 a[0:1], v252 offset:0
  ds_read_b64_tr_b16 a[2:3], v252 offset:1024
  ds_read_b64_tr_b16 a[4:5], v252 offset:2048
  ds_read_b64_tr_b16 a[6:7], v252 offset:3072
  ds_read_b64_tr_b16 a[8:9], v252 offset:3584
  ds_read_b64_tr_b16 a[10:11], v252 offset:4608
  ds_read_b64_tr_b16 a[12:13], v252 offset:5632
  ds_read_b64_tr_b16 a[14:15], v252 offset:6656
  ds_read_b64_tr_b16 a[16:17], v252 offset:7168
  ds_read_b64_tr_b16 a[18:19], v252 offset:8192
  ds_read_b64_tr_b16 a[20:21], v252 offset:9216
  ds_read_b64_tr_b16 a[22:23], v252 offset:10240
  s_waitcnt lgkmcnt(4)
  ds_read_b64_tr_b16 a[24:25], v252 offset:10752
  ds_read_b64_tr_b16 a[26:27], v252 offset:11776
  ds_read_b64_tr_b16 a[28:29], v252 offset:12800
  ds_read_b64_tr_b16 a[30:31], v252 offset:13824
  ds_read_b64_tr_b16 a[32:33], v252 offset:14336
  ds_read_b64_tr_b16 a[34:35], v252 offset:15360
  ds_read_b64_tr_b16 a[36:37], v252 offset:16384
  ds_read_b64_tr_b16 a[38:39], v252 offset:17408
  ds_read_b64_tr_b16 a[40:41], v252 offset:17920
  ds_read_b64_tr_b16 a[42:43], v252 offset:18944
  ds_read_b64_tr_b16 a[44:45], v252 offset:19968
  ds_read_b64_tr_b16 a[46:47], v252 offset:20992
  s_waitcnt lgkmcnt(4)
  ds_read_b64_tr_b16 a[48:49], v252 offset:21504
  ds_read_b64_tr_b16 a[50:51], v252 offset:22528
  ds_read_b64_tr_b16 a[52:53], v252 offset:23552
  ds_read_b64_tr_b16 a[54:55], v252 offset:24576
  ds_read_b64_tr_b16 a[56:57], v252 offset:25088
  ds_read_b64_tr_b16 a[58:59], v252 offset:26112
  ds_read_b64_tr_b16 a[60:61], v252 offset:27136
  ds_read_b64_tr_b16 a[62:63], v252 offset:28160
  ds_read_b64_tr_b16 a[64:65], v252 offset:28672
  ds_read_b64_tr_b16 a[66:67], v252 offset:29696
  ds_read_b64_tr_b16 a[68:69], v252 offset:30720
  ds_read_b64_tr_b16 a[70:71], v252 offset:31744
  s_waitcnt lgkmcnt(4)
  ds_read_b64_tr_b16 a[72:73], v252 offset:32256
  ds_read_b64_tr_b16 a[74:75], v252 offset:33280
  ds_read_b64_tr_b16 a[76:77], v252 offset:34304
  ds_read_b64_tr_b16 a[78:79], v252 offset:35328
  ds_read_b64_tr_b16 a[80:81], v252 offset:35840
  ds_read_b64_tr_b16 a[82:83], v252 offset:36864
  ds_read_b64_tr_b16 a[84:85], v252 offset:37888
  ds_read_b64_tr_b16 a[86:87], v252 offset:38912
  ds_read_b64_tr_b16 a[88:89], v252 offset:39424
  ds_read_b64_tr_b16 a[90:91], v252 offset:40448
  ds_read_b64_tr_b16 a[92:93], v252 offset:41472
  ds_read_b64_tr_b16 a[94:95], v252 offset:42496
  s_waitcnt lgkmcnt(4)
  ds_read_b64_tr_b16 a[96:97], v252 offset:43008
  ds_read_b64_tr_b16 a[98:99], v252 offset:44032
  ds_read_b64_tr_b16 a[100:101], v252 offset:45056
  ds_read_b64_tr_b16 a[102:103], v252 offset:46080
  ds_read_b64_tr_b16 a[104:105], v252 offset:46592
  ds_read_b64_tr_b16 a[106:107], v252 offset:47616
  ds_read_b64_tr_b16 a[108:109], v252 offset:48640
  ds_read_b64_tr_b16 a[110:111], v252 offset:49664
  ds_read_b64_tr_b16 a[112:113], v252 offset:50176
  ds_read_b64_tr_b16 a[114:115], v252 offset:51200
  ds_read_b64_tr_b16 a[116:117], v252 offset:52224
  ds_read_b64_tr_b16 a[118:119], v252 offset:53248
  s_waitcnt lgkmcnt(4)
  ds_read_b64_tr_b16 a[120:121], v252 offset:53760
  ds_read_b64_tr_b16 a[122:123], v252 offset:54784
  ds_read_b64_tr_b16 a[124:125], v252 offset:55808
  ds_read_b64_tr_b16 a[126:127], v252 offset:56832
  s_mov_b32 exec_lo, 0
  v_accvgpr_write_b32 a6, 0
  v_accvgpr_write_b32 a7, 0
  v_accvgpr_write_b32 a14, 0
  v_accvgpr_write_b32 a15, 0
  v_accvgpr_write_b32 a22, 0
  v_accvgpr_write_b32 a23, 0
  v_accvgpr_write_b32 a30, 0
  v_accvgpr_write_b32 a31, 0
  v_accvgpr_write_b32 a38, 0
  v_accvgpr_write_b32 a39, 0
  v_accvgpr_write_b32 a46, 0
  v_accvgpr_write_b32 a47, 0
  v_accvgpr_write_b32 a54, 0
  v_accvgpr_write_b32 a55, 0
  v_accvgpr_write_b32 a62, 0
  v_accvgpr_write_b32 a63, 0
  v_accvgpr_write_b32 a70, 0
  v_accvgpr_write_b32 a71, 0
  v_accvgpr_write_b32 a78, 0
  v_accvgpr_write_b32 a79, 0
  v_accvgpr_write_b32 a86, 0
  v_accvgpr_write_b32 a87, 0
  v_accvgpr_write_b32 a94, 0
  v_accvgpr_write_b32 a95, 0
  v_accvgpr_write_b32 a102, 0
  v_accvgpr_write_b32 a103, 0
  v_accvgpr_write_b32 a110, 0
  v_accvgpr_write_b32 a111, 0
  s_waitcnt lgkmcnt(4)
  v_accvgpr_write_b32 a118, 0
  v_accvgpr_write_b32 a119, 0
  s_waitcnt lgkmcnt(0)
  v_accvgpr_write_b32 a126, 0
  v_accvgpr_write_b32 a127, 0
  s_mov_b32 exec_lo, -1
  v_mul_u32_u24 v238, 896, v2
  v_lshl_add_u32 v238, v3, 3, v238
  s_mul_i32 s48, s95, 28672
  s_sub_u32 s49, s84, s48
  s_lshr_b32 s49, s49, 5
  s_add_u32 s48, s48, s49
  buffer_load_dwordx2 v[224:225], v238, s[64:67], s48 offen offset:0
  buffer_load_dwordx2 v[226:227], v238, s[64:67], s48 offen offset:16
  buffer_load_dwordx2 v[228:229], v238, s[64:67], s48 offen offset:32
  buffer_load_dwordx2 v[230:231], v238, s[64:67], s48 offen offset:48
  v_lshrrev_b32 v5, 4, v1
  v_lshrrev_b32 v4, 1, v5
  v_and_b32 v5, 1, v5
  v_lshl_add_u32 v4, v5, 3, v4
  s_lshl_b32 s48, s41, 4
  v_add_u32 v4, s48, v4
  v_lshlrev_b32 v4, 7, v4
  v_add_u32 v4, 15466496, v4
  s_mov_b64 exec, 65535
  s_mov_b32 s48, 400000
  s_waitcnt lgkmcnt(0)
poll_10:
  buffer_load_dword v6, v4, s[8:11], 0 offen sc1
  s_sub_u32 s48, s48, 1
  s_cbranch_scc1 k_end
  s_waitcnt vmcnt(0)
  v_cmp_le_u32 vcc, s62, v6
  s_nop 0
  s_cmp_eq_u64 vcc, exec
  s_cbranch_scc0 poll_10
  s_mov_b64 exec, -1
  buffer_load_dwordx4 v[40:43], v1, s[8:11], s22 offen offset:0 sc1
  buffer_load_dwordx4 v[44:47], v1, s[8:11], s22 offen offset:1024 sc1
  buffer_load_dwordx4 v[48:51], v1, s[8:11], s22 offen offset:2048 sc1
  buffer_load_dwordx4 v[52:55], v1, s[8:11], s22 offen offset:3072 sc1
  v_lshlrev_b32 v112, 16, v224
  v_and_b32 v113, 0xffff0000, v224
  v_lshlrev_b32 v114, 16, v225
  v_and_b32 v115, 0xffff0000, v225
  v_lshlrev_b32 v116, 16, v226
  v_and_b32 v117, 0xffff0000, v226
  v_lshlrev_b32 v118, 16, v227
  v_and_b32 v119, 0xffff0000, v227
  v_lshlrev_b32 v120, 16, v228
  v_and_b32 v121, 0xffff0000, v228
  v_lshlrev_b32 v122, 16, v229
  v_and_b32 v123, 0xffff0000, v229
  v_lshlrev_b32 v124, 16, v230
  v_and_b32 v125, 0xffff0000, v230
  v_lshlrev_b32 v126, 16, v231
  v_and_b32 v127, 0xffff0000, v231
  s_lshl_b32 s48, s4, 14
  s_and_b32 s48, s48, 0x8000
  s_add_u32 s48, s48, 86016
  v_add_u32 v236, s48, v1
  v_lshlrev_b32 v239, 3, v2
  v_lshl_add_u32 v239, v3, 2, v239
  s_lshr_b32 s50, s42, 1
  s_lshr_b32 s48, s50, 1
  s_and_b32 s49, s50, 1
  s_lshl_b32 s49, s49, 3
  s_add_u32 s48, s48, s49
  v_add_u32 v4, s48, v1
  v_lshlrev_b32 v4, 7, v4
  v_add_u32 v4, 15499264, v4
  s_waitcnt vmcnt(3)
  v_cvt_pk_bf16_f32 v40, v40, v41
  v_cvt_pk_bf16_f32 v41, v42, v43
  s_waitcnt vmcnt(2)
  v_cvt_pk_bf16_f32 v42, v44, v45
  v_cvt_pk_bf16_f32 v43, v46, v47
  s_nop 1
  v_mfma_f32_32x32x16_bf16 v[56:71], v[40:43], v[16:19], 0
  s_waitcnt vmcnt(1)
  v_cvt_pk_bf16_f32 v44, v48, v49
  v_cvt_pk_bf16_f32 v45, v50, v51
  s_waitcnt vmcnt(0)
  v_cvt_pk_bf16_f32 v46, v52, v53
  v_cvt_pk_bf16_f32 v47, v54, v55
  s_nop 1
  v_mfma_f32_32x32x16_bf16 v[56:71], v[44:47], v[20:23], v[56:71]
  s_nop 11
  v_add_f32 v232, s16, v68
  v_mov_b32 v233, v232
  s_nop 1
  v_permlane32_swap_b32 v233, v232
  v_rcp_f32 v232, v232
  s_nop 0
  v_pk_mul_f32 v[56:57], v[56:57], v[232:233] op_sel_hi:[1,0]
  v_cvt_pk_bf16_f32 v24, v56, v57
  v_pk_mul_f32 v[58:59], v[58:59], v[232:233] op_sel_hi:[1,0]
  v_cvt_pk_bf16_f32 v25, v58, v59
  v_pk_mul_f32 v[60:61], v[60:61], v[232:233] op_sel_hi:[1,0]
  v_cvt_pk_bf16_f32 v26, v60, v61
  v_pk_mul_f32 v[62:63], v[62:63], v[232:233] op_sel_hi:[1,0]
  v_cvt_pk_bf16_f32 v27, v62, v63
  v_pk_mul_f32 v[64:65], v[64:65], v[232:233] op_sel_hi:[1,0]
  v_cvt_pk_bf16_f32 v28, v64, v65
  v_pk_mul_f32 v[66:67], v[66:67], v[232:233] op_sel_hi:[1,0]
  v_cvt_pk_bf16_f32 v29, v66, v67
  v_pk_mul_f32 v[68:69], v[68:69], v[232:233] op_sel_hi:[1,0]
  v_cvt_pk_bf16_f32 v30, v68, v69
  v_pk_mul_f32 v[70:71], v[70:71], v[232:233] op_sel_hi:[1,0]
  v_cvt_pk_bf16_f32 v31, v70, v71
  s_cmp_lg_u32 s44, 0
  s_cbranch_scc1 ls_11
  buffer_store_dwordx4 v[24:27], v1, s[8:11], s12 offen sc1
  buffer_store_dwordx4 v[28:31], v1, s[8:11], s12 offen offset:1024 sc1
  s_branch ls_12
ls_11:
  buffer_store_dwordx4 v[24:27], v1, s[8:11], s12 offen
  buffer_store_dwordx4 v[28:31], v1, s[8:11], s12 offen offset:1024
ls_12:
  s_waitcnt vmcnt(0) lgkmcnt(0)
  s_barrier
  s_cmp_lg_u32 s4, 0
  s_cbranch_scc1 sig_13
  s_add_u32 s48, s62, 1
  v_mov_b32 v244, s48
  v_mov_b32 v246, 0
  s_mov_b64 exec, 1
  s_add_u32 s48, s46, 32768
  s_cmp_lg_u32 s44, 0
  s_cbranch_scc1 ls_14
  buffer_store_dword v244, v246, s[8:11], s48 offen sc1
  s_branch ls_15
ls_14:
  buffer_store_dword v244, v246, s[8:11], s48 offen
ls_15:
  s_mov_b64 exec, -1
  s_nop 1
sig_13:
  s_add_u32 s62, s62, 1
layer_loop:
  s_cmp_ge_u32 s43, 7
  s_cbranch_scc1 op_skip_17
  s_mov_b64 exec, 65535
  s_mov_b32 s48, 400000
  s_waitcnt lgkmcnt(0)
poll_18:
  buffer_load_dword v6, v4, s[8:11], 0 offen sc1
  s_sub_u32 s48, s48, 1
  s_cbranch_scc1 k_end
  s_waitcnt vmcnt(0)
  v_cmp_le_u32 vcc, s62, v6
  s_nop 0
  s_cmp_eq_u64 vcc, exec
  s_cbranch_scc0 poll_18
  s_mov_b64 exec, -1
  s_add_u32 m0, s92, 0
  s_add_u32 s17, s94, 2097152
  buffer_load_dwordx4 v1, s[8:11], s17 offen offset:0 sc1 lds
  buffer_load_dwordx4 v1, s[8:11], s17 offen offset:1024 sc1 lds
  s_add_u32 m0, s91, 4096
  s_add_u32 s17, s93, 2101248
  buffer_load_dwordx4 v1, s[8:11], s17 offen offset:0 sc1 lds
  buffer_load_dwordx4 v1, s[8:11], s17 offen offset:1024 sc1 lds
  buffer_load_dwordx4 v1, s[8:11], s17 offen offset:2048 sc1 lds
  buffer_load_dwordx4 v1, s[8:11], s17 offen offset:3072 sc1 lds
  s_add_u32 m0, s91, 12288
  s_add_u32 s17, s93, 2109440
  buffer_load_dwordx4 v1, s[8:11], s17 offen offset:0 sc1 lds
  buffer_load_dwordx4 v1, s[8:11], s17 offen offset:1024 sc1 lds
  buffer_load_dwordx4 v1, s[8:11], s17 offen offset:2048 sc1 lds
  buffer_load_dwordx4 v1, s[8:11], s17 offen offset:3072 sc1 lds
  s_add_u32 s51, s84, 0
  s_add_u32 s52, s85, 1835008
  s_mov_b32 s19, 1065369472
  s_waitcnt vmcnt(8)
  s_barrier
  ds_read_b128 v[32:35], v236 offset:0
  ds_read_b128 v[36:39], v236 offset:1024
  ds_read_b128 v[40:43], v236 offset:2048
  ds_read_b128 v[44:47], v236 offset:3072
  s_add_u32 m0, s91, 20480
  s_add_u32 s17, s93, 2117632
  buffer_load_dwordx4 v1, s[8:11], s17 offen offset:0 sc1 lds
  buffer_load_dwordx4 v1, s[8:11], s17 offen offset:1024 sc1 lds
  buffer_load_dwordx4 v1, s[8:11], s17 offen offset:2048 sc1 lds
  buffer_load_dwordx4 v1, s[8:11], s17 offen offset:3072 sc1 lds
  s_waitcnt lgkmcnt(3)
  v_mfma_f32_32x32x16_bf16 v[112:127], a[0:3], v[32:35], v[112:127]
  s_waitcnt lgkmcnt(2)
  v_mfma_f32_32x32x16_bf16 v[112:127], a[4:7], v[36:39], v[112:127]
  s_waitcnt vmcnt(8)
  s_barrier
  ds_read_b128 v[64:67], v236 offset:4096
  ds_read_b128 v[68:71], v236 offset:5120
  ds_read_b128 v[72:75], v236 offset:6144
  ds_read_b128 v[76:79], v236 offset:7168
  ds_read_b128 v[80:83], v236 offset:8192
  ds_read_b128 v[84:87], v236 offset:9216
  ds_read_b128 v[88:91], v236 offset:10240
  ds_read_b128 v[92:95], v236 offset:11264
  s_waitcnt lgkmcnt(9)
  v_mfma_f32_32x32x16_bf16 v[112:127], a[8:11], v[40:43], v[112:127]
  s_waitcnt lgkmcnt(8)
  v_mfma_f32_32x32x16_bf16 v[112:127], a[12:15], v[44:47], v[112:127]
  s_waitcnt lgkmcnt(7)
  v_mfma_f32_32x32x16_bf16 v[112:127], a[16:19], v[64:67], v[112:127]
  s_add_u32 m0, s92, 28672
  s_add_u32 s17, s94, 2125824
  buffer_load_dwordx4 v1, s[8:11], s17 offen offset:0 sc1 lds
  buffer_load_dwordx4 v1, s[8:11], s17 offen offset:1024 sc1 lds
  s_waitcnt lgkmcnt(6)
  v_mfma_f32_32x32x16_bf16 v[112:127], a[20:23], v[68:71], v[112:127]
  s_waitcnt lgkmcnt(5)
  v_mfma_f32_32x32x16_bf16 v[112:127], a[24:27], v[72:75], v[112:127]
  s_add_u32 m0, s61, 15360
  s_add_u32 s59, s60, 15360
  buffer_load_dwordx4 v1, s[8:11], s59 offen offset:1024 sc1 lds
  buffer_load_dwordx4 v1, s[8:11], s59 offen offset:2048 sc1 lds
  s_waitcnt lgkmcnt(4)
  v_mfma_f32_32x32x16_bf16 v[112:127], a[28:31], v[76:79], v[112:127]
  s_waitcnt lgkmcnt(3)
  v_mfma_f32_32x32x16_bf16 v[112:127], a[32:35], v[80:83], v[112:127]
  s_add_u32 m0, s61, 18432
  s_add_u32 s59, s60, 18432
  buffer_load_dwordx4 v1, s[8:11], s59 offen offset:1024 sc1 lds
  buffer_load_dwordx4 v1, s[8:11], s59 offen offset:2048 sc1 lds
  s_waitcnt lgkmcnt(2)
  v_mfma_f32_32x32x16_bf16 v[112:127], a[36:39], v[84:87], v[112:127]
  s_waitcnt vmcnt(10)
  s_barrier
  ds_read_b128 v[32:35], v236 offset:12288
  ds_read_b128 v[36:39], v236 offset:13312
  ds_read_b128 v[40:43], v236 offset:14336
  ds_read_b128 v[44:47], v236 offset:15360
  ds_read_b128 v[48:51], v236 offset:16384
  ds_read_b128 v[52:55], v236 offset:17408
  ds_read_b128 v[56:59], v236 offset:18432
  ds_read_b128 v[60:63], v236 offset:19456
  s_waitcnt lgkmcnt(9)
  v_mfma_f32_32x32x16_bf16 v[112:127], a[40:43], v[88:91], v[112:127]
  s_add_u32 m0, s61, 0
  s_add_u32 s59, s60, 0
  buffer_load_dwordx4 v1, s[8:11], s59 offen sc1 lds
  s_add_u32 m0, s61, 3072
  s_add_u32 s59, s60, 3072
  buffer_load_dwordx4 v1, s[8:11], s59 offen sc1 lds
  s_waitcnt lgkmcnt(8)
  v_mfma_f32_32x32x16_bf16 v[112:127], a[44:47], v[92:95], v[112:127]
  s_waitcnt lgkmcnt(7)
  v_mfma_f32_32x32x16_bf16 v[112:127], a[48:51], v[32:35], v[112:127]
  s_add_u32 m0, s61, 6144
  s_add_u32 s59, s60, 6144
  buffer_load_dwordx4 v1, s[8:11], s59 offen sc1 lds
  s_add_u32 m0, s61, 9216
  s_add_u32 s59, s60, 9216
  buffer_load_dwordx4 v1, s[8:11], s59 offen sc1 lds
  s_waitcnt lgkmcnt(6)
  v_mfma_f32_32x32x16_bf16 v[112:127], a[52:55], v[36:39], v[112:127]
  s_waitcnt lgkmcnt(5)
  v_mfma_f32_32x32x16_bf16 v[112:127], a[56:59], v[40:43], v[112:127]
  s_add_u32 m0, s61, 12288
  s_add_u32 s59, s60, 12288
  buffer_load_dwordx4 v1, s[8:11], s59 offen sc1 lds
  s_add_u32 m0, s61, 15360
  s_add_u32 s59, s60, 15360
  buffer_load_dwordx4 v1, s[8:11], s59 offen sc1 lds
  s_waitcnt lgkmcnt(4)
  v_mfma_f32_32x32x16_bf16 v[112:127], a[60:63], v[44:47], v[112:127]
  s_waitcnt lgkmcnt(3)
  v_mfma_f32_32x32x16_bf16 v[112:127], a[64:67], v[48:51], v[112:127]
  s_add_u32 m0, s61, 18432
  s_add_u32 s59, s60, 18432
  buffer_load_dwordx4 v1, s[8:11], s59 offen sc1 lds
  s_waitcnt lgkmcnt(2)
  v_mfma_f32_32x32x16_bf16 v[112:127], a[68:71], v[52:55], v[112:127]
  s_waitcnt vmcnt(13)
  s_barrier
  ds_read_b128 v[64:67], v236 offset:20480
  ds_read_b128 v[68:71], v236 offset:21504
  ds_read_b128 v[72:75], v236 offset:22528
  ds_read_b128 v[76:79], v236 offset:23552
  ds_read_b128 v[80:83], v236 offset:24576
  ds_read_b128 v[84:87], v236 offset:25600
  ds_read_b128 v[88:91], v236 offset:26624
  ds_read_b128 v[92:95], v236 offset:27648
  s_waitcnt lgkmcnt(9)
  v_mfma_f32_32x32x16_bf16 v[112:127], a[72:75], v[56:59], v[112:127]
  s_waitcnt lgkmcnt(8)
  v_mfma_f32_32x32x16_bf16 v[112:127], a[76:79], v[60:63], v[112:127]
  s_waitcnt lgkmcnt(7)
  v_mfma_f32_32x32x16_bf16 v[112:127], a[80:83], v[64:67], v[112:127]
  s_waitcnt lgkmcnt(6)
  v_mfma_f32_32x32x16_bf16 v[112:127], a[84:87], v[68:71], v[112:127]
  s_waitcnt lgkmcnt(5)
  v_mfma_f32_32x32x16_bf16 v[112:127], a[88:91], v[72:75], v[112:127]
  s_waitcnt lgkmcnt(4)
  v_mfma_f32_32x32x16_bf16 v[112:127], a[92:95], v[76:79], v[112:127]
  s_waitcnt lgkmcnt(3)
  v_mfma_f32_32x32x16_bf16 v[112:127], a[96:99], v[80:83], v[112:127]
  s_waitcnt lgkmcnt(2)
  v_mfma_f32_32x32x16_bf16 v[112:127], a[100:103], v[84:87], v[112:127]
  s_waitcnt vmcnt(11)
  s_barrier
  ds_read_b128 v[32:35], v236 offset:28672
  ds_read_b128 v[36:39], v236 offset:29696
  ds_read_b128 v[40:43], v236 offset:30720
  ds_read_b128 v[44:47], v236 offset:31744
  s_waitcnt lgkmcnt(5)
  v_mfma_f32_32x32x16_bf16 v[112:127], a[104:107], v[88:91], v[112:127]
  s_waitcnt lgkmcnt(4)
  v_mfma_f32_32x32x16_bf16 v[112:127], a[108:111], v[92:95], v[112:127]
  s_waitcnt lgkmcnt(3)
  v_mfma_f32_32x32x16_bf16 v[112:127], a[112:115], v[32:35], v[112:127]
  s_waitcnt lgkmcnt(2)
  v_mfma_f32_32x32x16_bf16 v[112:127], a[116:119], v[36:39], v[112:127]
  s_waitcnt lgkmcnt(1)
  v_mfma_f32_32x32x16_bf16 v[112:127], a[120:123], v[40:43], v[112:127]
  s_waitcnt lgkmcnt(0)
  v_mfma_f32_32x32x16_bf16 v[112:127], a[124:127], v[44:47], v[112:127]
  s_nop 11
  v_cvt_pk_bf16_f32 v224, v112, v113
  v_cvt_pk_bf16_f32 v225, v114, v115
  v_cvt_pk_bf16_f32 v226, v116, v117
  v_cvt_pk_bf16_f32 v227, v118, v119
  v_cvt_pk_bf16_f32 v228, v120, v121
  v_cvt_pk_bf16_f32 v229, v122, v123
  v_cvt_pk_bf16_f32 v230, v124, v125
  v_cvt_pk_bf16_f32 v231, v126, v127
  s_cmp_lg_u32 s44, 0
  s_cbranch_scc1 ls_19
  buffer_store_dwordx4 v[224:227], v1, s[8:11], s51 offen sc1
  buffer_store_dwordx4 v[228:231], v1, s[8:11], s51 offen offset:1024 sc1
  s_branch ls_20
ls_19:
  buffer_store_dwordx4 v[224:227], v1, s[8:11], s51 offen
  buffer_store_dwordx4 v[228:231], v1, s[8:11], s51 offen offset:1024
ls_20:
  v_dot2_f32_bf16 v232, v224, s19, 0
  v_dot2_f32_bf16 v233, v224, v224, 0
  v_dot2_f32_bf16 v232, v225, s19, v232
  v_dot2_f32_bf16 v233, v225, v225, v233
  v_dot2_f32_bf16 v232, v226, s19, v232
  v_dot2_f32_bf16 v233, v226, v226, v233
  v_dot2_f32_bf16 v232, v227, s19, v232
  v_dot2_f32_bf16 v233, v227, v227, v233
  v_dot2_f32_bf16 v232, v228, s19, v232
  v_dot2_f32_bf16 v233, v228, v228, v233
  v_dot2_f32_bf16 v232, v229, s19, v232
  v_dot2_f32_bf16 v233, v229, v229, v233
  v_dot2_f32_bf16 v232, v230, s19, v232
  v_dot2_f32_bf16 v233, v230, v230, v233
  v_dot2_f32_bf16 v232, v231, s19, v232
  v_dot2_f32_bf16 v233, v231, v231, v233
  s_nop 2
  v_permlane32_swap_b32 v232, v233
  v_add_f32 v232, v232, v233
  s_cmp_lg_u32 s44, 0
  s_cbranch_scc1 ls_21
  buffer_store_dword v232, v239, s[8:11], s52 offen sc1
  s_branch ls_22
ls_21:
  buffer_store_dword v232, v239, s[8:11], s52 offen
ls_22:
  s_lshl_b32 s7, s40, 2
  s_add_u32 s7, s7, s4
  s_mul_i32 s20, s7, 28672
  s_add_u32 s20, s20, 0
  s_lshl_b32 s21, s7, 8
  s_add_u32 s21, s21, 1835008
  s_add_u32 s20, s20, s47
  s_add_u32 s21, s21, s47
  v_lshlrev_b32 v243, 3, v2
  v_lshl_add_u32 v243, v3, 14, v243
  s_lshl_b32 s18, s4, 7
  s_add_u32 s18, s18, 159744
  v_lshl_add_u32 v240, v2, 2, s18
  v_lshl_add_u32 v241, v3, 4, s18
  s_mov_b32 s17, 0x07060302
  s_add_u32 s87, s86, 2097152
  s_add_u32 s87, s87, s47
  s_add_u32 s88, s84, 0
  s_add_u32 s88, s88, s47
  s_add_u32 s89, s85, 1835008
  s_add_u32 s89, s89, s47
  v_lshlrev_b32 v250, 1, v1
  v_lshrrev_b32 v5, 4, v1
  s_lshr_b32 s48, s7, 3
  s_lshr_b32 s49, s7, 1
  s_and_b32 s49, s49, 3
  s_lshl_b32 s49, s49, 3
  s_add_u32 s48, s48, s49
  v_lshl_add_u32 v4, v5, 5, s48
  v_lshlrev_b32 v4, 7, v4
  v_add_u32 v4, 15499264, v4
  v_cmp_eq_u32 s[56:57], 0, v3
  s_nop 1
  v_cndmask_b32 v16, 0, v12, s[56:57]
  v_and_b32 v17, 0xffff0000, v16
  v_sub_f32 v16, v16, v17
  v_and_b32 v18, 0xffff0000, v16
  v_sub_f32 v19, v16, v18
  v_perm_b32 v220, v18, v17, s17
  v_perm_b32 v221, v17, v19, s17
  v_perm_b32 v222, v17, v18, s17
  v_mov_b32 v223, 0
  v_cndmask_b32 v16, 0, v13, s[56:57]
  v_and_b32 v17, 0xffff0000, v16
  v_sub_f32 v16, v16, v17
  v_and_b32 v18, 0xffff0000, v16
  v_sub_f32 v19, v16, v18
  v_perm_b32 v224, v18, v17, s17
  v_perm_b32 v225, v17, v19, s17
  v_perm_b32 v226, v17, v18, s17
  v_mov_b32 v227, 0
  v_cndmask_b32 v16, 0, v11, s[56:57]
  v_and_b32 v17, 0xffff0000, v16
  v_sub_f32 v16, v16, v17
  v_and_b32 v18, 0xffff0000, v16
  v_sub_f32 v19, v16, v18
  v_perm_b32 v216, v18, v17, s17
  v_perm_b32 v217, v17, v19, s17
  v_perm_b32 v218, v17, v18, s17
  v_mov_b32 v219, 0
  v_lshrrev_b32 v251, 7, v1
  v_mul_u32_u24 v251, 896, v251
  v_lshrrev_b32 v252, 2, v1
  v_and_b32 v252, 64, v252
  v_xor_b32 v252, v252, v1
  v_and_b32 v252, 0x70, v252
  s_min_u32 s48, s43, 6
  s_lshl_b32 s48, s48, 7
  v_add3_u32 v251, v251, v252, s48
  s_mul_i32 s26, s4, 100352
  s_mul_i32 s27, s4, 14336
  s_cmp_lg_u32 s63, 0
  s_cselect_b32 s26, 1073741824, s26
  ds_read_b128 v[176:179], v1 offset:1024
  ds_read_b128 v[180:183], v1 offset:2048
  ds_read_b128 v[184:187], v1 offset:4096
  ds_read_b128 v[188:191], v1 offset:5120
  ds_read_b128 v[192:195], v1 offset:7168
  s_waitcnt vmcnt(0) lgkmcnt(0)
  s_barrier
  s_cmp_lg_u32 s4, 0
  s_cbranch_scc1 sig_23
  s_add_u32 s48, s62, 1
  v_mov_b32 v244, s48
  v_mov_b32 v246, 0
  s_mov_b64 exec, 1
  s_add_u32 s48, s46, 32768
  s_cmp_lg_u32 s44, 0
  s_cbranch_scc1 ls_24
  buffer_store_dword v244, v246, s[8:11], s48 offen sc1
  s_branch ls_25
ls_24:
  buffer_store_dword v244, v246, s[8:11], s48 offen
ls_25:
  s_mov_b64 exec, -1
  s_nop 1
sig_23:
  s_branch op_join_16
op_skip_17:
  s_add_u32 m0, s61, 15360
  s_add_u32 s59, s60, 15360
  buffer_load_dwordx4 v1, s[8:11], s59 offen offset:1024 sc1 lds
  buffer_load_dwordx4 v1, s[8:11], s59 offen offset:2048 sc1 lds
  s_add_u32 m0, s61, 18432
  s_add_u32 s59, s60, 18432
  buffer_load_dwordx4 v1, s[8:11], s59 offen offset:1024 sc1 lds
  buffer_load_dwordx4 v1, s[8:11], s59 offen offset:2048 sc1 lds
  s_add_u32 m0, s61, 0
  s_add_u32 s59, s60, 0
  buffer_load_dwordx4 v1, s[8:11], s59 offen sc1 lds
  s_add_u32 m0, s61, 3072
  s_add_u32 s59, s60, 3072
  buffer_load_dwordx4 v1, s[8:11], s59 offen sc1 lds
  s_add_u32 m0, s61, 6144
  s_add_u32 s59, s60, 6144
  buffer_load_dwordx4 v1, s[8:11], s59 offen sc1 lds
  s_add_u32 m0, s61, 9216
  s_add_u32 s59, s60, 9216
  buffer_load_dwordx4 v1, s[8:11], s59 offen sc1 lds
  s_add_u32 m0, s61, 12288
  s_add_u32 s59, s60, 12288
  buffer_load_dwordx4 v1, s[8:11], s59 offen sc1 lds
  s_add_u32 m0, s61, 15360
  s_add_u32 s59, s60, 15360
  buffer_load_dwordx4 v1, s[8:11], s59 offen sc1 lds
  s_add_u32 m0, s61, 18432
  s_add_u32 s59, s60, 18432
  buffer_load_dwordx4 v1, s[8:11], s59 offen sc1 lds
  s_waitcnt vmcnt(0)
  s_barrier
  s_lshl_b32 s7, s40, 2
  s_add_u32 s7, s7, s4
  s_mul_i32 s20, s7, 28672
  s_add_u32 s20, s20, 0
  s_lshl_b32 s21, s7, 8
  s_add_u32 s21, s21, 1835008
  s_add_u32 s20, s20, s47
  s_add_u32 s21, s21, s47
  v_lshlrev_b32 v243, 3, v2
  v_lshl_add_u32 v243, v3, 14, v243
  s_lshl_b32 s18, s4, 7
  s_add_u32 s18, s18, 159744
  v_lshl_add_u32 v240, v2, 2, s18
  v_lshl_add_u32 v241, v3, 4, s18
  s_mov_b32 s17, 0x07060302
  s_add_u32 s87, s86, 2097152
  s_add_u32 s87, s87, s47
  s_add_u32 s88, s84, 0
  s_add_u32 s88, s88, s47
  s_add_u32 s89, s85, 1835008
  s_add_u32 s89, s89, s47
  v_lshlrev_b32 v250, 1, v1
  v_lshrrev_b32 v5, 4, v1
  s_lshr_b32 s48, s7, 3
  s_lshr_b32 s49, s7, 1
  s_and_b32 s49, s49, 3
  s_lshl_b32 s49, s49, 3
  s_add_u32 s48, s48, s49
  v_lshl_add_u32 v4, v5, 5, s48
  v_lshlrev_b32 v4, 7, v4
  v_add_u32 v4, 15499264, v4
  v_cmp_eq_u32 s[56:57], 0, v3
  s_nop 1
  v_cndmask_b32 v16, 0, v12, s[56:57]
  v_and_b32 v17, 0xffff0000, v16
  v_sub_f32 v16, v16, v17
  v_and_b32 v18, 0xffff0000, v16
  v_sub_f32 v19, v16, v18
  v_perm_b32 v220, v18, v17, s17
  v_perm_b32 v221, v17, v19, s17
  v_perm_b32 v222, v17, v18, s17
  v_mov_b32 v223, 0
  v_cndmask_b32 v16, 0, v13, s[56:57]
  v_and_b32 v17, 0xffff0000, v16
  v_sub_f32 v16, v16, v17
  v_and_b32 v18, 0xffff0000, v16
  v_sub_f32 v19, v16, v18
  v_perm_b32 v224, v18, v17, s17
  v_perm_b32 v225, v17, v19, s17
  v_perm_b32 v226, v17, v18, s17
  v_mov_b32 v227, 0
  v_cndmask_b32 v16, 0, v11, s[56:57]
  v_and_b32 v17, 0xffff0000, v16
  v_sub_f32 v16, v16, v17
  v_and_b32 v18, 0xffff0000, v16
  v_sub_f32 v19, v16, v18
  v_perm_b32 v216, v18, v17, s17
  v_perm_b32 v217, v17, v19, s17
  v_perm_b32 v218, v17, v18, s17
  v_mov_b32 v219, 0
  v_lshrrev_b32 v251, 7, v1
  v_mul_u32_u24 v251, 896, v251
  v_lshrrev_b32 v252, 2, v1
  v_and_b32 v252, 64, v252
  v_xor_b32 v252, v252, v1
  v_and_b32 v252, 0x70, v252
  s_min_u32 s48, s43, 6
  s_lshl_b32 s48, s48, 7
  v_add3_u32 v251, v251, v252, s48
  s_mul_i32 s26, s4, 100352
  s_mul_i32 s27, s4, 14336
  s_cmp_lg_u32 s63, 0
  s_cselect_b32 s26, 1073741824, s26
  ds_read_b128 v[176:179], v1 offset:1024
  ds_read_b128 v[180:183], v1 offset:2048
  ds_read_b128 v[184:187], v1 offset:4096
  ds_read_b128 v[188:191], v1 offset:5120
  ds_read_b128 v[192:195], v1 offset:7168
  s_waitcnt vmcnt(0) lgkmcnt(0)
  s_barrier
op_join_16:
  s_add_u32 s62, s62, 1
  s_mov_b64 exec, 127
  s_mov_b32 s48, 400000
  s_waitcnt lgkmcnt(0)
poll_26:
  buffer_load_dword v6, v4, s[8:11], 0 offen sc1
  s_sub_u32 s48, s48, 1
  s_cbranch_scc1 k_end
  s_waitcnt vmcnt(0)
  v_cmp_le_u32 vcc, s62, v6
  s_nop 0
  s_cmp_eq_u64 vcc, exec
  s_cbranch_scc0 poll_26
  s_mov_b64 exec, -1
  buffer_load_dwordx4 v[16:19], v1, s[8:11], s20 offen offset:0 sc1
  buffer_load_dwordx4 v[20:23], v1, s[8:11], s20 offen offset:1024 sc1
  buffer_load_dwordx4 v[24:27], v1, s[8:11], s20 offen offset:2048 sc1
  buffer_load_dwordx4 v[28:31], v1, s[8:11], s20 offen offset:3072 sc1
  s_add_u32 s20, s20, 4096
  buffer_load_dwordx4 v[32:35], v1, s[8:11], s20 offen offset:0 sc1
  buffer_load_dwordx4 v[36:39], v1, s[8:11], s20 offen offset:1024 sc1
  buffer_load_dwordx4 v[40:43], v1, s[8:11], s20 offen offset:2048 sc1
  buffer_load_dwordx4 v[44:47], v1, s[8:11], s20 offen offset:3072 sc1
  s_add_u32 s20, s20, 4096
  s_waitcnt vmcnt(7)
  v_mfma_f32_32x32x16_bf16 v[128:143], v[176:179], v[16:19], 0
  buffer_load_dwordx4 v[48:51], v1, s[8:11], s20 offen offset:0 sc1
  buffer_load_dwordx4 v[52:55], v1, s[8:11], s20 offen offset:1024 sc1
  ds_read_b128 v[196:199], v1 offset:8192
  v_mfma_f32_32x32x16_bf16 v[144:159], v[16:19], v[180:183], 0
  buffer_load_dwordx2 v[160:161], v243, s[8:11], s21 offen sc1
  s_add_u32 s21, s21, 32768
  buffer_load_dwordx2 v[162:163], v243, s[8:11], s21 offen sc1
  s_add_u32 s21, s21, 32768
  buffer_load_dwordx2 v[164:165], v243, s[8:11], s21 offen sc1
  s_add_u32 s21, s21, 32768
  buffer_load_dwordx2 v[166:167], v243, s[8:11], s21 offen sc1
  s_add_u32 s21, s21, 32768
  buffer_load_dwordx2 v[168:169], v243, s[8:11], s21 offen sc1
  s_add_u32 s21, s21, 32768
  buffer_load_dwordx2 v[170:171], v243, s[8:11], s21 offen sc1
  s_add_u32 s21, s21, 32768
  buffer_load_dwordx2 v[172:173], v243, s[8:11], s21 offen sc1
  ds_read_b128 v[176:179], v1 offset:10240
  s_waitcnt vmcnt(15)
  v_mfma_f32_32x32x16_bf16 v[128:143], v[184:187], v[20:23], v[128:143]
  buffer_load_dwordx4 v[56:59], v1, s[8:11], s20 offen offset:2048 sc1
  buffer_load_dwordx4 v[60:63], v1, s[8:11], s20 offen offset:3072 sc1
  s_add_u32 s20, s20, 4096
  ds_read_b128 v[180:183], v1 offset:11264
  v_mfma_f32_32x32x16_bf16 v[144:159], v[20:23], v[188:191], v[144:159]
  ds_read_b128 v[184:187], v1 offset:13312
  s_waitcnt vmcnt(16)
  v_mfma_f32_32x32x16_bf16 v[128:143], v[192:195], v[24:27], v[128:143]
  buffer_load_dwordx4 v[64:67], v1, s[8:11], s20 offen offset:0 sc1
  buffer_load_dwordx4 v[68:71], v1, s[8:11], s20 offen offset:1024 sc1
  ds_read_b128 v[188:191], v1 offset:14336
  s_waitcnt lgkmcnt(4)
  v_mfma_f32_32x32x16_bf16 v[144:159], v[24:27], v[196:199], v[144:159]
  ds_read_b128 v[192:195], v1 offset:16384
  s_waitcnt vmcnt(17) lgkmcnt(4)
  v_mfma_f32_32x32x16_bf16 v[128:143], v[176:179], v[28:31], v[128:143]
  buffer_load_dwordx4 v[72:75], v1, s[8:11], s20 offen offset:2048 sc1
  buffer_load_dwordx4 v[76:79], v1, s[8:11], s20 offen offset:3072 sc1
  s_add_u32 s20, s20, 4096
  ds_read_b128 v[196:199], v1 offset:17408
  s_waitcnt lgkmcnt(4)
  v_mfma_f32_32x32x16_bf16 v[144:159], v[28:31], v[180:183], v[144:159]
  ds_read_b128 v[176:179], v1 offset:19456
  s_waitcnt vmcnt(18) lgkmcnt(4)
  v_mfma_f32_32x32x16_bf16 v[128:143], v[184:187], v[32:35], v[128:143]
  buffer_load_dwordx4 v[80:83], v1, s[8:11], s20 offen offset:0 sc1
  buffer_load_dwordx4 v[84:87], v1, s[8:11], s20 offen offset:1024 sc1
  ds_read_b128 v[180:183], v1 offset:20480
  s_waitcnt lgkmcnt(4)
  v_mfma_f32_32x32x16_bf16 v[144:159], v[32:35], v[188:191], v[144:159]
  ds_read_b128 v[184:187], v1 offset:22528
  s_waitcnt vmcnt(19) lgkmcnt(4)
  v_mfma_f32_32x32x16_bf16 v[128:143], v[192:195], v[36:39], v[128:143]
  buffer_load_dwordx4 v[88:91], v1, s[8:11], s20 offen offset:2048 sc1
  buffer_load_dwordx4 v[92:95], v1, s[8:11], s20 offen offset:3072 sc1
  s_add_u32 s20, s20, 4096
  ds_read_b128 v[188:191], v1 offset:23552
  s_waitcnt lgkmcnt(4)
  v_mfma_f32_32x32x16_bf16 v[144:159], v[36:39], v[196:199], v[144:159]
  ds_read_b128 v[192:195], v1 offset:25600
  s_waitcnt vmcnt(20) lgkmcnt(4)
  v_mfma_f32_32x32x16_bf16 v[128:143], v[176:179], v[40:43], v[128:143]
  buffer_load_dwordx4 v[96:99], v1, s[8:11], s20 offen offset:0 sc1
  ds_read_b128 v[196:199], v1 offset:26624
  s_waitcnt lgkmcnt(4)
  v_mfma_f32_32x32x16_bf16 v[144:159], v[40:43], v[180:183], v[144:159]
  ds_read_b128 v[176:179], v1 offset:28672
  s_waitcnt vmcnt(20) lgkmcnt(4)
  v_mfma_f32_32x32x16_bf16 v[128:143], v[184:187], v[44:47], v[128:143]
  buffer_load_dwordx4 v[100:103], v1, s[8:11], s20 offen offset:1024 sc1
  ds_read_b128 v[180:183], v1 offset:29696
  s_waitcnt lgkmcnt(4)
  v_mfma_f32_32x32x16_bf16 v[144:159], v[44:47], v[188:191], v[144:159]
  ds_read_b128 v[184:187], v1 offset:31744
  s_waitcnt vmcnt(20) lgkmcnt(4)
  v_mfma_f32_32x32x16_bf16 v[128:143], v[192:195], v[48:51], v[128:143]
  buffer_load_dwordx4 v[104:107], v1, s[8:11], s20 offen offset:2048 sc1
  ds_read_b128 v[188:191], v1 offset:32768
  s_waitcnt lgkmcnt(4)
  v_mfma_f32_32x32x16_bf16 v[144:159], v[48:51], v[196:199], v[144:159]
  ds_read_b128 v[192:195], v1 offset:34816
  s_waitcnt vmcnt(20) lgkmcnt(4)
  v_mfma_f32_32x32x16_bf16 v[128:143], v[176:179], v[52:55], v[128:143]
  buffer_load_dwordx4 v[108:111], v1, s[8:11], s20 offen offset:3072 sc1
  s_add_u32 s20, s20, 4096
  ds_read_b128 v[196:199], v1 offset:35840
  s_waitcnt lgkmcnt(4)
  v_mfma_f32_32x32x16_bf16 v[144:159], v[52:55], v[180:183], v[144:159]
  ds_read_b128 v[176:179], v1 offset:37888
  s_waitcnt vmcnt(13) lgkmcnt(4)
  v_mfma_f32_32x32x16_bf16 v[128:143], v[184:187], v[56:59], v[128:143]
  buffer_load_dwordx4 v[112:115], v1, s[8:11], s20 offen offset:0 sc1
  ds_read_b128 v[180:183], v1 offset:38912
  s_waitcnt lgkmcnt(4)
  v_mfma_f32_32x32x16_bf16 v[144:159], v[56:59], v[188:191], v[144:159]
  ds_read_b128 v[184:187], v1 offset:40960
  s_waitcnt vmcnt(13) lgkmcnt(4)
  v_mfma_f32_32x32x16_bf16 v[128:143], v[192:195], v[60:63], v[128:143]
  buffer_load_dwordx4 v[116:119], v1, s[8:11], s20 offen offset:1024 sc1
  ds_read_b128 v[188:191], v1 offset:41984
  s_waitcnt lgkmcnt(4)
  v_mfma_f32_32x32x16_bf16 v[144:159], v[60:63], v[196:199], v[144:159]
  ds_read_b128 v[192:195], v1 offset:44032
  s_waitcnt vmcnt(13) lgkmcnt(4)
  v_mfma_f32_32x32x16_bf16 v[128:143], v[176:179], v[64:67], v[128:143]
  buffer_load_dwordx4 v[120:123], v1, s[8:11], s20 offen offset:2048 sc1
  ds_read_b128 v[196:199], v1 offset:45056
  v_add_f32 v160, v160, v162
  v_add_f32 v161, v161, v163
  s_waitcnt lgkmcnt(4)
  v_mfma_f32_32x32x16_bf16 v[144:159], v[64:67], v[180:183], v[144:159]
  ds_read_b128 v[176:179], v1 offset:47104
  v_add_f32 v160, v160, v164
  v_add_f32 v161, v161, v165
  s_waitcnt vmcnt(13) lgkmcnt(4)
  v_mfma_f32_32x32x16_bf16 v[128:143], v[184:187], v[68:71], v[128:143]
  buffer_load_dwordx4 v[124:127], v1, s[8:11], s20 offen offset:3072 sc1
  ds_read_b128 v[180:183], v1 offset:48128
  v_add_f32 v160, v160, v166
  v_add_f32 v161, v161, v167
  s_waitcnt lgkmcnt(4)
  v_mfma_f32_32x32x16_bf16 v[144:159], v[68:71], v[188:191], v[144:159]
  ds_read_b128 v[184:187], v1 offset:50176
  v_add_f32 v160, v160, v168
  v_add_f32 v161, v161, v169
  s_waitcnt vmcnt(13) lgkmcnt(4)
  v_mfma_f32_32x32x16_bf16 v[128:143], v[192:195], v[72:75], v[128:143]
  ds_read_b128 v[188:191], v1 offset:51200
  v_add_f32 v160, v160, v170
  v_add_f32 v161, v161, v171
  s_waitcnt lgkmcnt(4)
  v_mfma_f32_32x32x16_bf16 v[144:159], v[72:75], v[196:199], v[144:159]
  ds_read_b128 v[192:195], v1 offset:53248
  v_add_f32 v160, v160, v172
  v_add_f32 v161, v161, v173
  s_waitcnt vmcnt(12) lgkmcnt(4)
  v_mfma_f32_32x32x16_bf16 v[128:143], v[176:179], v[76:79], v[128:143]
  ds_read_b128 v[196:199], v1 offset:54272
  v_mov_b32 v162, v160
  v_mov_b32 v163, v161
  s_waitcnt lgkmcnt(4)
  v_mfma_f32_32x32x16_bf16 v[144:159], v[76:79], v[180:183], v[144:159]
  ds_read_b128 v[176:179], v1 offset:56320
  v_permlane32_swap_b32 v160, v162
  v_permlane32_swap_b32 v161, v163
  s_waitcnt vmcnt(11) lgkmcnt(4)
  v_mfma_f32_32x32x16_bf16 v[128:143], v[184:187], v[80:83], v[128:143]
  ds_read_b128 v[180:183], v1 offset:57344
  v_add_f32 v160, v160, v162
  v_add_f32 v161, v161, v163
  s_waitcnt lgkmcnt(4)
  v_mfma_f32_32x32x16_bf16 v[144:159], v[80:83], v[188:191], v[144:159]
  ds_read_b128 v[184:187], v1 offset:59392
  s_mov_b32 s16, 0x3b124925
  v_mul_f32 v160, s16, v160
  s_waitcnt vmcnt(10) lgkmcnt(4)
  v_mfma_f32_32x32x16_bf16 v[128:143], v[192:195], v[84:87], v[128:143]
  ds_read_b128 v[188:191], v1 offset:60416
  v_mul_f32 v161, s16, v161
  v_fma_f32 v161, -v160, v160, v161
  s_waitcnt lgkmcnt(4)
  v_mfma_f32_32x32x16_bf16 v[144:159], v[84:87], v[196:199], v[144:159]
  buffer_load_dword v255, v250, s[8:11], s87 offen sc1
  buffer_load_dword v255, v250, s[8:11], s88 offen sc1
  s_mov_b64 exec, 0xff
  buffer_load_dword v255, v250, s[8:11], s89 offen sc1
  s_mov_b64 exec, -1
  ds_read_b128 v[192:195], v1 offset:62464
  v_max_f32 v161, 0, v161
  v_add_f32 v161, 0x3727c5ac, v161
  s_waitcnt vmcnt(12) lgkmcnt(4)
  v_mfma_f32_32x32x16_bf16 v[128:143], v[176:179], v[88:91], v[128:143]
  ds_read_b128 v[196:199], v1 offset:63488
  v_rsq_f32 v232, v161
  v_sub_f32 v160, 0, v160
  s_waitcnt lgkmcnt(4)
  v_mfma_f32_32x32x16_bf16 v[144:159], v[88:91], v[180:183], v[144:159]
  ds_read_b128 v[176:179], v14 offset:0
  ds_write_b32 v240, v232
  ds_read_b128 v[200:203], v241 offset:0
  s_waitcnt vmcnt(11) lgkmcnt(6)
  v_mfma_f32_32x32x16_bf16 v[128:143], v[184:187], v[92:95], v[128:143]
  ds_read_b128 v[180:183], v14 offset:1024
  ds_read_b128 v[204:207], v241 offset:32
  ds_read_b128 v[208:211], v241 offset:64
  s_waitcnt lgkmcnt(8)
  v_mfma_f32_32x32x16_bf16 v[144:159], v[92:95], v[188:191], v[144:159]
  ds_read_b128 v[184:187], v14 offset:3072
  ds_read_b128 v[212:215], v241 offset:96
  v_and_b32 v236, 0xffff0000, v160
  s_waitcnt vmcnt(10) lgkmcnt(9)
  v_mfma_f32_32x32x16_bf16 v[128:143], v[192:195], v[96:99], v[128:143]
  ds_read_b128 v[188:191], v14 offset:4096
  v_sub_f32 v237, v160, v236
  v_and_b32 v238, 0xffff0000, v237
  s_waitcnt lgkmcnt(9)
  v_mfma_f32_32x32x16_bf16 v[144:159], v[96:99], v[196:199], v[144:159]
  ds_read_b128 v[192:195], v14 offset:6144
  v_sub_f32 v239, v237, v238
  v_perm_b32 v228, v236, v236, s17
  s_waitcnt vmcnt(9) lgkmcnt(9)
  v_mfma_f32_32x32x16_bf16 v[128:143], v[176:179], v[100:103], v[128:143]
  ds_read_b128 v[196:199], v14 offset:7168
  v_perm_b32 v229, v238, v236, s17
  v_perm_b32 v230, v239, v238, s17
  s_waitcnt lgkmcnt(7)
  v_mfma_f32_32x32x16_bf16 v[144:159], v[100:103], v[180:183], v[144:159]
  ds_read_b128 v[176:179], v14 offset:9216
  v_mov_b32 v231, 0
  v_mul_f32 v234, 0x3e8b97f6, v232
  s_waitcnt vmcnt(8) lgkmcnt(5)
  v_mfma_f32_32x32x16_bf16 v[128:143], v[184:187], v[104:107], v[128:143]
  ds_read_b128 v[180:183], v14 offset:10240
  s_waitcnt lgkmcnt(4)
  v_mfma_f32_32x32x16_bf16 v[144:159], v[104:107], v[188:191], v[144:159]
  ds_read_b128 v[184:187], v14 offset:12288
  s_waitcnt vmcnt(7) lgkmcnt(4)
  v_mfma_f32_32x32x16_bf16 v[128:143], v[192:195], v[108:111], v[128:143]
  ds_read_b128 v[188:191], v14 offset:13312
  s_waitcnt lgkmcnt(4)
  v_mfma_f32_32x32x16_bf16 v[144:159], v[108:111], v[196:199], v[144:159]
  ds_read_b128 v[192:195], v14 offset:15360
  v_mfma_f32_32x32x16_bf16 v[128:143], v[220:223], v[228:231], v[128:143]
  v_mfma_f32_32x32x16_bf16 v[144:159], v[228:231], v[224:227], v[144:159]
  s_waitcnt vmcnt(6) lgkmcnt(4)
  v_mfma_f32_32x32x16_bf16 v[128:143], v[176:179], v[112:115], v[128:143]
  ds_read_b128 v[196:199], v14 offset:16384
  s_waitcnt lgkmcnt(4)
  v_mfma_f32_32x32x16_bf16 v[144:159], v[112:115], v[180:183], v[144:159]
  ds_read_b128 v[176:179], v14 offset:18432
  s_waitcnt vmcnt(5) lgkmcnt(4)
  v_mfma_f32_32x32x16_bf16 v[128:143], v[184:187], v[116:119], v[128:143]
  ds_read_b128 v[180:183], v14 offset:19456
  s_waitcnt lgkmcnt(4)
  v_mfma_f32_32x32x16_bf16 v[144:159], v[116:119], v[188:191], v[144:159]
  ds_read_b128 v[184:187], v1 offset:0
  s_waitcnt vmcnt(4) lgkmcnt(4)
  v_mfma_f32_32x32x16_bf16 v[128:143], v[192:195], v[120:123], v[128:143]
  ds_read_b128 v[188:191], v1 offset:3072
  s_waitcnt lgkmcnt(4)
  v_mfma_f32_32x32x16_bf16 v[144:159], v[120:123], v[196:199], v[144:159]
  ds_read_b128 v[192:195], v1 offset:6144
  s_waitcnt vmcnt(3) lgkmcnt(4)
  v_mfma_f32_32x32x16_bf16 v[128:143], v[176:179], v[124:127], v[128:143]
  ds_read_b128 v[196:199], v1 offset:9216
  s_waitcnt lgkmcnt(4)
  v_mfma_f32_32x32x16_bf16 v[144:159], v[124:127], v[180:183], v[144:159]
  ds_read_b128 v[176:179], v1 offset:12288
  s_mov_b32 s19, 1065369472
  s_lshl_b32 s12, s41, 18
  s_lshl_b32 s13, s7, 12
  s_add_u32 s12, s12, s13
  s_add_u32 s13, s12, 4194304
  s_add_u32 s13, s13, s90
  s_nop 1
  v_pk_mul_f32 v[128:129], v[128:129], v[232:233] op_sel_hi:[1,0]
  v_cvt_pk_bf16_f32 v128, v128, v129
  v_pk_mul_f32 v[130:131], v[130:131], v[232:233] op_sel_hi:[1,0]
  v_cvt_pk_bf16_f32 v129, v130, v131
  v_pk_mul_f32 v[132:133], v[132:133], v[232:233] op_sel_hi:[1,0]
  v_cvt_pk_bf16_f32 v130, v132, v133
  v_pk_mul_f32 v[134:135], v[134:135], v[232:233] op_sel_hi:[1,0]
  v_cvt_pk_bf16_f32 v131, v134, v135
  buffer_store_dwordx4 v[128:131], v1, s[8:11], s13 offen sc1
  v_pk_mul_f32 v[136:137], v[136:137], v[232:233] op_sel_hi:[1,0]
  v_cvt_pk_bf16_f32 v132, v136, v137
  v_pk_mul_f32 v[138:139], v[138:139], v[232:233] op_sel_hi:[1,0]
  v_cvt_pk_bf16_f32 v133, v138, v139
  v_pk_mul_f32 v[140:141], v[140:141], v[232:233] op_sel_hi:[1,0]
  v_cvt_pk_bf16_f32 v134, v140, v141
  v_pk_mul_f32 v[142:143], v[142:143], v[232:233] op_sel_hi:[1,0]
  v_cvt_pk_bf16_f32 v135, v142, v143
  s_mov_b32 exec_lo, 0
  v_mov_b32 v134, s19
  v_mov_b32 v135, 0
  s_mov_b32 exec_lo, -1
  buffer_store_dwordx4 v[132:135], v1, s[8:11], s13 offen offset:1024 sc1
  v_pk_mul_f32 v[144:145], v[144:145], v[200:201]
  v_cvt_pk_bf16_f32 v136, v144, v145
  v_pk_mul_f32 v[146:147], v[146:147], v[202:203]
  v_cvt_pk_bf16_f32 v137, v146, v147
  v_pk_mul_f32 v[148:149], v[148:149], v[204:205]
  v_cvt_pk_bf16_f32 v138, v148, v149
  v_pk_mul_f32 v[150:151], v[150:151], v[206:207]
  v_cvt_pk_bf16_f32 v139, v150, v151
  v_pk_mul_f32 v[152:153], v[152:153], v[208:209]
  v_cvt_pk_bf16_f32 v140, v152, v153
  v_pk_mul_f32 v[154:155], v[154:155], v[210:211]
  v_cvt_pk_bf16_f32 v141, v154, v155
  v_pk_mul_f32 v[156:157], v[156:157], v[212:213]
  v_cvt_pk_bf16_f32 v142, v156, v157
  v_pk_mul_f32 v[158:159], v[158:159], v[214:215]
  v_cvt_pk_bf16_f32 v143, v158, v159
  s_mov_b32 exec_lo, 0xf0000000
  s_mov_b32 exec_hi, 0xf0000000
  v_mov_b32 v136, v15
  v_mov_b32 v137, v15
  v_mov_b32 v138, v15
  v_mov_b32 v139, v15
  v_mov_b32 v140, v15
  v_mov_b32 v141, v15
  v_mov_b32 v142, v15
  v_mov_b32 v143, v15
  s_mov_b64 exec, -1
  v_permlane32_swap_b32 v136, v138
  v_permlane32_swap_b32 v137, v139
  v_permlane32_swap_b32 v140, v142
  v_permlane32_swap_b32 v141, v143
  buffer_store_dwordx4 v[136:139], v1, s[8:11], s13 offen offset:2048 sc1
  buffer_store_dwordx4 v[140:143], v1, s[8:11], s13 offen offset:3072 sc1
  v_mfma_f32_32x32x16_bf16 v[160:175], v[216:219], v[228:231], 0
  s_waitcnt lgkmcnt(4)
  v_mfma_f32_32x32x16_bf16 v[160:175], v[184:187], v[16:19], v[160:175]
  ds_read_b128 v[180:183], v1 offset:15360
  s_add_u32 m0, s27, 86016
  s_add_u32 s25, s26, 0
  buffer_load_dwordx4 v251, s[80:83], s25 offen lds
  s_waitcnt lgkmcnt(4)
  v_mfma_f32_32x32x16_bf16 v[160:175], v[188:191], v[20:23], v[160:175]
  ds_read_b128 v[184:187], v1 offset:18432
  s_add_u32 m0, s27, 87040
  s_add_u32 s25, s26, 7168
  buffer_load_dwordx4 v251, s[80:83], s25 offen lds
  s_waitcnt lgkmcnt(4)
  v_mfma_f32_32x32x16_bf16 v[160:175], v[192:195], v[24:27], v[160:175]
  ds_read_b128 v[188:191], v1 offset:21504
  s_add_u32 m0, s27, 88064
  s_add_u32 s25, s26, 14336
  buffer_load_dwordx4 v251, s[80:83], s25 offen lds
  s_waitcnt lgkmcnt(4)
  v_mfma_f32_32x32x16_bf16 v[160:175], v[196:199], v[28:31], v[160:175]
  ds_read_b128 v[192:195], v1 offset:24576
  s_add_u32 m0, s27, 89088
  s_add_u32 s25, s26, 21504
  buffer_load_dwordx4 v251, s[80:83], s25 offen lds
  s_waitcnt lgkmcnt(4)
  v_mfma_f32_32x32x16_bf16 v[160:175], v[176:179], v[32:35], v[160:175]
  ds_read_b128 v[196:199], v1 offset:27648
  s_add_u32 m0, s27, 90112
  s_add_u32 s25, s26, 28672
  buffer_load_dwordx4 v251, s[80:83], s25 offen lds
  s_waitcnt lgkmcnt(4)
  v_mfma_f32_32x32x16_bf16 v[160:175], v[180:183], v[36:39], v[160:175]
  ds_read_b128 v[176:179], v1 offset:30720
  s_add_u32 m0, s27, 91136
  s_add_u32 s25, s26, 35840
  buffer_load_dwordx4 v251, s[80:83], s25 offen lds
  s_waitcnt lgkmcnt(4)
  v_mfma_f32_32x32x16_bf16 v[160:175], v[184:187], v[40:43], v[160:175]
  ds_read_b128 v[180:183], v1 offset:33792
  s_add_u32 m0, s27, 92160
  s_add_u32 s25, s26, 43008
  buffer_load_dwordx4 v251, s[80:83], s25 offen lds
  s_waitcnt lgkmcnt(4)
  v_mfma_f32_32x32x16_bf16 v[160:175], v[188:191], v[44:47], v[160:175]
  ds_read_b128 v[184:187], v1 offset:36864
  s_add_u32 m0, s27, 93184
  s_add_u32 s25, s26, 50176
  buffer_load_dwordx4 v251, s[80:83], s25 offen lds
  s_waitcnt lgkmcnt(4)
  v_mfma_f32_32x32x16_bf16 v[160:175], v[192:195], v[48:51], v[160:175]
  ds_read_b128 v[188:191], v1 offset:39936
  s_add_u32 m0, s27, 94208
  s_add_u32 s25, s26, 57344
  buffer_load_dwordx4 v251, s[80:83], s25 offen lds
  s_waitcnt lgkmcnt(4)
  v_mfma_f32_32x32x16_bf16 v[160:175], v[196:199], v[52:55], v[160:175]
  ds_read_b128 v[192:195], v1 offset:43008
  v_mov_b32 v48, 0
  v_mov_b32 v49, 0
  v_mov_b32 v50, 0
  v_mov_b32 v51, 0
  s_add_u32 m0, s27, 95232
  s_add_u32 s25, s26, 64512
  buffer_load_dwordx4 v251, s[80:83], s25 offen lds
  s_waitcnt lgkmcnt(4)
  v_mfma_f32_32x32x16_bf16 v[160:175], v[176:179], v[56:59], v[160:175]
  ds_read_b128 v[196:199], v1 offset:46080
  v_mov_b32 v52, 0
  v_mov_b32 v53, 0
  v_mov_b32 v54, 0
  v_mov_b32 v55, 0
  s_add_u32 m0, s27, 96256
  s_add_u32 s25, s26, 71680
  buffer_load_dwordx4 v251, s[80:83], s25 offen lds
  s_waitcnt lgkmcnt(4)
  v_mfma_f32_32x32x16_bf16 v[160:175], v[180:183], v[60:63], v[160:175]
  ds_read_b128 v[176:179], v1 offset:49152
  v_mov_b32 v56, 0
  v_mov_b32 v57, 0
  v_mov_b32 v58, 0
  v_mov_b32 v59, 0
  s_add_u32 m0, s27, 97280
  s_add_u32 s25, s26, 78848
  buffer_load_dwordx4 v251, s[80:83], s25 offen lds
  s_waitcnt lgkmcnt(4)
  v_mfma_f32_32x32x16_bf16 v[160:175], v[184:187], v[64:67], v[160:175]
  ds_read_b128 v[180:183], v1 offset:52224
  v_mov_b32 v60, 0
  v_mov_b32 v61, 0
  v_mov_b32 v62, 0
  v_mov_b32 v63, 0
  s_add_u32 m0, s27, 98304
  s_add_u32 s25, s26, 86016
  buffer_load_dwordx4 v251, s[80:83], s25 offen lds
  s_waitcnt lgkmcnt(4)
  v_mfma_f32_32x32x16_bf16 v[160:175], v[188:191], v[68:71], v[160:175]
  ds_read_b128 v[184:187], v1 offset:55296
  v_mov_b32 v64, 0
  v_mov_b32 v65, 0
  v_mov_b32 v66, 0
  v_mov_b32 v67, 0
  s_add_u32 m0, s27, 99328
  s_add_u32 s25, s26, 93184
  buffer_load_dwordx4 v251, s[80:83], s25 offen lds
  s_waitcnt lgkmcnt(4)
  v_mfma_f32_32x32x16_bf16 v[160:175], v[192:195], v[72:75], v[160:175]
  ds_read_b128 v[188:191], v1 offset:58368
  v_mov_b32 v68, 0
  v_mov_b32 v69, 0
  v_mov_b32 v70, 0
  v_mov_b32 v71, 0
  s_waitcnt lgkmcnt(4)
  v_mfma_f32_32x32x16_bf16 v[160:175], v[196:199], v[76:79], v[160:175]
  ds_read_b128 v[192:195], v1 offset:61440
  v_mov_b32 v72, 0
  v_mov_b32 v73, 0
  v_mov_b32 v74, 0
  v_mov_b32 v75, 0
  s_waitcnt lgkmcnt(4)
  v_mfma_f32_32x32x16_bf16 v[160:175], v[176:179], v[80:83], v[160:175]
  ds_read_b128 v[196:199], v1 offset:64512
  v_mov_b32 v76, 0
  v_mov_b32 v77, 0
  v_mov_b32 v78, 0
  v_mov_b32 v79, 0
  s_waitcnt lgkmcnt(4)
  v_mfma_f32_32x32x16_bf16 v[160:175], v[180:183], v[84:87], v[160:175]
  ds_read_b128 v[176:179], v14 offset:2048
  v_mov_b32 v80, 0
  v_mov_b32 v81, 0
  v_mov_b32 v82, 0
  v_mov_b32 v83, 0
  s_waitcnt lgkmcnt(4)
  v_mfma_f32_32x32x16_bf16 v[160:175], v[184:187], v[88:91], v[160:175]
  ds_read_b128 v[180:183], v14 offset:5120
  v_mov_b32 v84, 0
  v_mov_b32 v85, 0
  v_mov_b32 v86, 0
  v_mov_b32 v87, 0
  s_waitcnt lgkmcnt(4)
  v_mfma_f32_32x32x16_bf16 v[160:175], v[188:191], v[92:95], v[160:175]
  ds_read_b128 v[184:187], v14 offset:8192
  v_mov_b32 v88, 0
  v_mov_b32 v89, 0
  v_mov_b32 v90, 0
  v_mov_b32 v91, 0
  s_waitcnt lgkmcnt(4)
  v_mfma_f32_32x32x16_bf16 v[160:175], v[192:195], v[96:99], v[160:175]
  ds_read_b128 v[188:191], v14 offset:11264
  v_mov_b32 v92, 0
  v_mov_b32 v93, 0
  v_mov_b32 v94, 0
  v_mov_b32 v95, 0
  s_waitcnt lgkmcnt(4)
  v_mfma_f32_32x32x16_bf16 v[160:175], v[196:199], v[100:103], v[160:175]
  ds_read_b128 v[192:195], v14 offset:14336
  v_mov_b32 v96, 0
  v_mov_b32 v97, 0
  v_mov_b32 v98, 0
  v_mov_b32 v99, 0
  s_waitcnt lgkmcnt(4)
  v_mfma_f32_32x32x16_bf16 v[160:175], v[176:179], v[104:107], v[160:175]
  ds_read_b128 v[196:199], v14 offset:17408
  v_mov_b32 v100, 0
  v_mov_b32 v101, 0
  v_mov_b32 v102, 0
  v_mov_b32 v103, 0
  s_waitcnt lgkmcnt(4)
  v_mfma_f32_32x32x16_bf16 v[160:175], v[180:183], v[108:111], v[160:175]
  v_mov_b32 v104, 0
  v_mov_b32 v105, 0
  v_mov_b32 v106, 0
  v_mov_b32 v107, 0
  s_waitcnt lgkmcnt(3)
  v_mfma_f32_32x32x16_bf16 v[160:175], v[184:187], v[112:115], v[160:175]
  v_mov_b32 v108, 0
  v_mov_b32 v109, 0
  v_mov_b32 v110, 0
  v_mov_b32 v111, 0
  s_waitcnt vmcnt(14)
  s_barrier
  s_cmp_lg_u32 s4, 0
  s_cbranch_scc1 sig_27
  s_add_u32 s48, s62, 1
  v_mov_b32 v4, s48
  v_mov_b32 v6, 0
  s_mov_b64 exec, 1
  buffer_store_dword v4, v6, s[8:11], s46 offen sc1
  s_mov_b64 exec, -1
  s_nop 1
sig_27:
  s_add_u32 s62, s62, 1
  s_waitcnt lgkmcnt(2)
  v_mfma_f32_32x32x16_bf16 v[160:175], v[188:191], v[116:119], v[160:175]
  s_waitcnt lgkmcnt(1)
  v_mfma_f32_32x32x16_bf16 v[160:175], v[192:195], v[120:123], v[160:175]
  s_waitcnt lgkmcnt(0)
  v_mfma_f32_32x32x16_bf16 v[160:175], v[196:199], v[124:127], v[160:175]
  s_nop 11
  v_pk_mul_f32 v[160:161], v[160:161], v[234:235] op_sel_hi:[1,0]
  v_cvt_pk_bf16_f32 v16, v160, v161
  v_pk_mul_f32 v[162:163], v[162:163], v[234:235] op_sel_hi:[1,0]
  v_cvt_pk_bf16_f32 v17, v162, v163
  v_pk_mul_f32 v[164:165], v[164:165], v[234:235] op_sel_hi:[1,0]
  v_cvt_pk_bf16_f32 v18, v164, v165
  v_pk_mul_f32 v[166:167], v[166:167], v[234:235] op_sel_hi:[1,0]
  v_cvt_pk_bf16_f32 v19, v166, v167
  v_pk_mul_f32 v[168:169], v[168:169], v[234:235] op_sel_hi:[1,0]
  v_cvt_pk_bf16_f32 v20, v168, v169
  v_pk_mul_f32 v[170:171], v[170:171], v[234:235] op_sel_hi:[1,0]
  v_cvt_pk_bf16_f32 v21, v170, v171
  v_pk_mul_f32 v[172:173], v[172:173], v[234:235] op_sel_hi:[1,0]
  v_cvt_pk_bf16_f32 v22, v172, v173
  v_pk_mul_f32 v[174:175], v[174:175], v[234:235] op_sel_hi:[1,0]
  v_cvt_pk_bf16_f32 v23, v174, v175
  s_mov_b32 exec_lo, 0
  v_mov_b32 v22, 0
  v_mov_b32 v23, 0
  s_mov_b32 exec_lo, -1
  v_mfma_f32_32x32x16_bf16 v[144:159], v[128:131], v[16:19], 0
  v_mfma_f32_32x32x16_bf16 v[144:159], v[132:135], v[20:23], v[144:159]
  s_lshl_b32 s12, s4, 11
  s_add_u32 s13, s12, 143360
  v_add_u32 v240, s13, v1
  ds_write_b128 v240, v[16:19]
  s_xor_b32 s13, s12, 2048
  s_add_u32 s13, s13, 143360
  v_add_u32 v241, s13, v1
  s_xor_b32 s13, s12, 4096
  s_add_u32 s13, s13, 143360
  v_add_u32 v242, s13, v1
  s_xor_b32 s13, s12, 6144
  s_add_u32 s13, s13, 143360
  v_add_u32 v243, s13, v1
  v_max3_f32 v236, v144, v145, v146
  v_max3_f32 v237, v147, v148, v149
  v_max3_f32 v236, v150, v151, v236
  v_max3_f32 v237, v152, v153, v237
  v_max3_f32 v236, v154, v155, v236
  v_max3_f32 v237, v156, v157, v237
  v_max3_f32 v236, v158, v159, v236
  v_max_f32 v236, v236, v237
  v_mov_b32 v237, v236
  s_nop 1
  v_permlane32_swap_b32 v236, v237
  v_max_f32 v236, v236, v237
  v_sub_f32 v236, 0, v236
  v_and_b32 v237, 0xffff0000, v236
  v_sub_f32 v238, v236, v237
  s_mov_b32 exec_lo, 0
  v_perm_b32 v22, v238, v237, s17
  s_mov_b32 exec_lo, -1
  ds_write_b128 v240, v[20:23] offset:1024
  s_waitcnt vmcnt(0)
  s_waitcnt lgkmcnt(0)
  s_barrier
  ds_read_b128 v[24:27], v241 offset:0
  ds_read_b128 v[28:31], v241 offset:1024
  ds_read_b128 v[32:35], v242 offset:0
  ds_read_b128 v[36:39], v242 offset:1024
  ds_read_b128 v[40:43], v243 offset:0
  ds_read_b128 v[44:47], v243 offset:1024
  s_waitcnt lgkmcnt(5)
  v_mfma_f32_32x32x16_bf16 v[176:191], v[128:131], v[24:27], 0
  s_waitcnt lgkmcnt(4)
  v_mfma_f32_32x32x16_bf16 v[176:191], v[132:135], v[28:31], v[176:191]
  s_waitcnt lgkmcnt(3)
  v_mfma_f32_32x32x16_bf16 v[192:207], v[128:131], v[32:35], 0
  s_waitcnt lgkmcnt(2)
  v_mfma_f32_32x32x16_bf16 v[192:207], v[132:135], v[36:39], v[192:207]
  v_mov_b32 v248, 0xdddd
  s_lshl_b32 s12, s41, 18
  s_add_u32 s12, s12, 4194304
  s_add_u32 s12, s12, s90
  s_mul_i32 s13, s4, 15
  s_lshl_b32 s16, s40, 2
  s_cmp_ge_u32 s13, s16
  s_cselect_b32 s18, 4, 0
  s_add_u32 s18, s18, s13
  s_lshl_b32 s18, s18, 12
  s_add_u32 s18, s18, s12
  s_add_u32 s14, s8, s18
  s_addc_u32 s15, s9, 0
  v_lshrrev_b32 v5, 4, v1
  v_lshrrev_b32 v4, 1, v5
  v_and_b32 v5, 1, v5
  v_lshl_add_u32 v4, v5, 3, v4
  s_lshl_b32 s48, s41, 4
  v_add_u32 v4, s48, v4
  v_lshlrev_b32 v4, 7, v4
  v_add_u32 v4, 15466496, v4
  v_exp_f32 v176, v176
  v_exp_f32 v177, v177
  v_exp_f32 v178, v178
  v_exp_f32 v179, v179
  v_exp_f32 v180, v180
  v_exp_f32 v181, v181
  v_exp_f32 v182, v182
  v_exp_f32 v183, v183
  s_waitcnt lgkmcnt(1)
  v_mfma_f32_32x32x16_bf16 v[208:223], v[128:131], v[40:43], 0
  s_mov_b32 s19, 20480
  v_exp_f32 v184, v184
  v_exp_f32 v185, v185
  v_exp_f32 v186, v186
  v_exp_f32 v187, v187
  v_smfmac_f32_32x32x32_bf16 v[64:79], v[136:139], v[176:183], v248
  s_mov_b32 s24, 4096
  buffer_load_dword v6, v4, s[8:11], 0 offen sc1
  v_exp_f32 v188, v188
  v_exp_f32 v189, v189
  v_exp_f32 v190, v190
  v_exp_f32 v191, v191
  s_waitcnt lgkmcnt(0)
  v_mfma_f32_32x32x16_bf16 v[208:223], v[132:135], v[44:47], v[208:223]
  s_mov_b32 s17, 4
  v_exp_f32 v192, v192
  v_exp_f32 v193, v193
  v_exp_f32 v194, v194
  v_exp_f32 v195, v195
  v_smfmac_f32_32x32x32_bf16 v[64:79], v[140:143], v[184:191], v248
  s_mov_b32 s20, 0x1f800000
  v_exp_f32 v196, v196
  v_exp_f32 v197, v197
  v_exp_f32 v198, v198
  v_exp_f32 v199, v199
  v_mfma_f32_32x32x16_bf16 v[176:191], v[128:131], v[16:19], 0
  s_mov_b32 s21, 0x5f800000
  v_exp_f32 v200, v200
  v_exp_f32 v201, v201
  v_exp_f32 v202, v202
  v_exp_f32 v203, v203
  v_smfmac_f32_32x32x32_bf16 v[80:95], v[136:139], v[192:199], v248
  s_add_u32 s51, s86, 2097152
  v_exp_f32 v204, v204
  v_exp_f32 v205, v205
  v_exp_f32 v206, v206
  v_exp_f32 v207, v207
  v_mfma_f32_32x32x16_bf16 v[176:191], v[132:135], v[20:23], v[176:191]
  s_add_u32 s51, s51, s47
  v_exp_f32 v208, v208
  v_exp_f32 v209, v209
  v_exp_f32 v210, v210
  v_exp_f32 v211, v211
  v_smfmac_f32_32x32x32_bf16 v[80:95], v[140:143], v[200:207], v248
  s_waitcnt vmcnt(0)
  v_cmp_le_u32 vcc, s62, v6
  s_nop 0
  s_and_b32 s48, vcc_lo, 0xffff
  s_cmp_eq_u32 s48, 0xffff
  s_cbranch_scc1 look_28
  s_mov_b64 exec, 65535
  s_mov_b32 s48, 400000
  s_waitcnt lgkmcnt(0)
poll_29:
  buffer_load_dword v6, v4, s[8:11], 0 offen sc1
  s_sub_u32 s48, s48, 1
  s_cbranch_scc1 k_end
  s_waitcnt vmcnt(0)
  v_cmp_le_u32 vcc, s62, v6
  s_nop 0
  s_cmp_eq_u64 vcc, exec
  s_cbranch_scc0 poll_29
  s_mov_b64 exec, -1
look_28:
  global_load_dwordx4 v[144:147], v1, s[14:15] offset:0 sc1
  global_load_dwordx4 v[148:151], v1, s[14:15] offset:1024 sc1
  global_load_dwordx4 v[152:155], v1, s[14:15] offset:2048 sc1
  global_load_dwordx4 v[156:159], v1, s[14:15] offset:3072 sc1
  s_add_u32 s13, s13, 1
  s_cmp_eq_u32 s13, s16
  s_cselect_b32 s18, s19, s24
  s_add_u32 s14, s14, s18
  s_addc_u32 s15, s15, 0
  global_load_dwordx4 v[160:163], v1, s[14:15] offset:0 sc1
  global_load_dwordx4 v[164:167], v1, s[14:15] offset:1024 sc1
  global_load_dwordx4 v[168:171], v1, s[14:15] offset:2048 sc1
  global_load_dwordx4 v[172:175], v1, s[14:15] offset:3072 sc1
  v_exp_f32 v212, v212
  v_exp_f32 v213, v213
  v_exp_f32 v214, v214
  v_exp_f32 v215, v215
  v_exp_f32 v216, v216
  v_exp_f32 v217, v217
  v_exp_f32 v218, v218
  v_exp_f32 v219, v219
  v_smfmac_f32_32x32x32_bf16 v[96:111], v[136:139], v[208:215], v248
  v_exp_f32 v220, v220
  v_exp_f32 v221, v221
  v_exp_f32 v222, v222
  v_exp_f32 v223, v223
  v_exp_f32 v176, v176
  v_exp_f32 v177, v177
  v_exp_f32 v178, v178
  v_exp_f32 v179, v179
  v_smfmac_f32_32x32x32_bf16 v[96:111], v[140:143], v[216:223], v248
  v_exp_f32 v180, v180
  v_exp_f32 v181, v181
  v_exp_f32 v182, v182
  v_exp_f32 v183, v183
  v_exp_f32 v184, v184
  v_exp_f32 v185, v185
  v_exp_f32 v186, v186
  v_exp_f32 v187, v187
  v_smfmac_f32_32x32x32_bf16 v[48:63], v[136:139], v[176:183], v248
  v_exp_f32 v188, v188
  v_exp_f32 v189, v189
  v_exp_f32 v190, v190
  v_exp_f32 v191, v191
  s_nop 1
  v_smfmac_f32_32x32x32_bf16 v[48:63], v[140:143], v[184:191], v248
  s_add_u32 s13, s13, 1
  s_cmp_eq_u32 s13, s16
  s_cselect_b32 s18, s19, s24
  s_add_u32 s14, s14, s18
  s_addc_u32 s15, s15, 0
  s_mul_i32 s61, s4, 21504
  s_mul_i32 s60, s41, 86016
  s_add_u32 s60, s60, s61
  s_add_u32 s60, s60, 12582912
  s_cmp_lg_u32 s63, 0
  s_cselect_b32 s60, 1073741824, s60
  s_xor_b32 s22, s4, 1
  s_mul_i32 s22, s22, 12288
  s_add_u32 s22, s22, 90112
  v_add_u32 v116, s22, v1
  s_xor_b32 s22, s4, 2
  s_mul_i32 s22, s22, 12288
  s_add_u32 s22, s22, 94208
  v_add_u32 v117, s22, v1
  s_xor_b32 s22, s4, 3
  s_mul_i32 s22, s22, 12288
  s_add_u32 s22, s22, 98304
  v_add_u32 v118, s22, v1
  s_mul_i32 s22, s4, 12288
  s_add_u32 s22, s22, 90112
  v_add_u32 v115, s22, v1
  s_cmp_lg_u32 s63, 0
  s_cbranch_scc1 wob_30
  v_bfe_u32 v252, v1, 6, 2
  v_lshl_add_u32 v252, v3, 2, v252
  v_lshlrev_b32 v252, 7, v252
  v_bfe_u32 v253, v1, 7, 1
  s_and_b32 s49, s4, 1
  v_xor_b32 v253, s49, v253
  v_lshl_add_u32 v252, v253, 6, v252
  v_bfe_u32 v253, v1, 8, 1
  v_lshl_add_u32 v252, v253, 5, v252
  v_bfe_u32 v253, v1, 4, 2
  v_lshl_add_u32 v252, v253, 3, v252
  v_add_u32 v252, 86016, v252
  ds_read_b64_tr_b16 a[128:129], v252 offset:0
  ds_read_b64_tr_b16 a[130:131], v252 offset:1024
  ds_read_b64_tr_b16 a[132:133], v252 offset:2048
  ds_read_b64_tr_b16 a[134:135], v252 offset:3072
  ds_read_b64_tr_b16 a[136:137], v252 offset:3584
  ds_read_b64_tr_b16 a[138:139], v252 offset:4608
  ds_read_b64_tr_b16 a[140:141], v252 offset:5632
  ds_read_b64_tr_b16 a[142:143], v252 offset:6656
  ds_read_b64_tr_b16 a[144:145], v252 offset:7168
  ds_read_b64_tr_b16 a[146:147], v252 offset:8192
  ds_read_b64_tr_b16 a[148:149], v252 offset:9216
  ds_read_b64_tr_b16 a[150:151], v252 offset:10240
  s_waitcnt lgkmcnt(4)
  ds_read_b64_tr_b16 a[152:153], v252 offset:10752
  ds_read_b64_tr_b16 a[154:155], v252 offset:11776
  ds_read_b64_tr_b16 a[156:157], v252 offset:12800
  ds_read_b64_tr_b16 a[158:159], v252 offset:13824
  ds_read_b64_tr_b16 a[160:161], v252 offset:14336
  ds_read_b64_tr_b16 a[162:163], v252 offset:15360
  ds_read_b64_tr_b16 a[164:165], v252 offset:16384
  ds_read_b64_tr_b16 a[166:167], v252 offset:17408
  ds_read_b64_tr_b16 a[168:169], v252 offset:17920
  ds_read_b64_tr_b16 a[170:171], v252 offset:18944
  ds_read_b64_tr_b16 a[172:173], v252 offset:19968
  ds_read_b64_tr_b16 a[174:175], v252 offset:20992
  s_waitcnt lgkmcnt(4)
  ds_read_b64_tr_b16 a[176:177], v252 offset:21504
  ds_read_b64_tr_b16 a[178:179], v252 offset:22528
  ds_read_b64_tr_b16 a[180:181], v252 offset:23552
  ds_read_b64_tr_b16 a[182:183], v252 offset:24576
  ds_read_b64_tr_b16 a[184:185], v252 offset:25088
  ds_read_b64_tr_b16 a[186:187], v252 offset:26112
  ds_read_b64_tr_b16 a[188:189], v252 offset:27136
  ds_read_b64_tr_b16 a[190:191], v252 offset:28160
  ds_read_b64_tr_b16 a[192:193], v252 offset:28672
  ds_read_b64_tr_b16 a[194:195], v252 offset:29696
  ds_read_b64_tr_b16 a[196:197], v252 offset:30720
  ds_read_b64_tr_b16 a[198:199], v252 offset:31744
  s_waitcnt lgkmcnt(4)
  ds_read_b64_tr_b16 a[200:201], v252 offset:32256
  ds_read_b64_tr_b16 a[202:203], v252 offset:33280
  ds_read_b64_tr_b16 a[204:205], v252 offset:34304
  ds_read_b64_tr_b16 a[206:207], v252 offset:35328
  ds_read_b64_tr_b16 a[208:209], v252 offset:35840
  ds_read_b64_tr_b16 a[210:211], v252 offset:36864
  ds_read_b64_tr_b16 a[212:213], v252 offset:37888
  ds_read_b64_tr_b16 a[214:215], v252 offset:38912
  ds_read_b64_tr_b16 a[216:217], v252 offset:39424
  ds_read_b64_tr_b16 a[218:219], v252 offset:40448
  ds_read_b64_tr_b16 a[220:221], v252 offset:41472
  ds_read_b64_tr_b16 a[222:223], v252 offset:42496
  s_waitcnt lgkmcnt(4)
  ds_read_b64_tr_b16 a[224:225], v252 offset:43008
  ds_read_b64_tr_b16 a[226:227], v252 offset:44032
  ds_read_b64_tr_b16 a[228:229], v252 offset:45056
  ds_read_b64_tr_b16 a[230:231], v252 offset:46080
  ds_read_b64_tr_b16 a[232:233], v252 offset:46592
  ds_read_b64_tr_b16 a[234:235], v252 offset:47616
  ds_read_b64_tr_b16 a[236:237], v252 offset:48640
  ds_read_b64_tr_b16 a[238:239], v252 offset:49664
  ds_read_b64_tr_b16 a[240:241], v252 offset:50176
  ds_read_b64_tr_b16 a[242:243], v252 offset:51200
  ds_read_b64_tr_b16 a[244:245], v252 offset:52224
  ds_read_b64_tr_b16 a[246:247], v252 offset:53248
  s_waitcnt lgkmcnt(4)
  ds_read_b64_tr_b16 a[248:249], v252 offset:53760
  ds_read_b64_tr_b16 a[250:251], v252 offset:54784
  ds_read_b64_tr_b16 a[252:253], v252 offset:55808
  ds_read_b64_tr_b16 a[254:255], v252 offset:56832
  s_mov_b32 exec_lo, 0
  v_accvgpr_write_b32 a134, 0
  v_accvgpr_write_b32 a135, 0
  v_accvgpr_write_b32 a142, 0
  v_accvgpr_write_b32 a143, 0
  v_accvgpr_write_b32 a150, 0
  v_accvgpr_write_b32 a151, 0
  v_accvgpr_write_b32 a158, 0
  v_accvgpr_write_b32 a159, 0
  v_accvgpr_write_b32 a166, 0
  v_accvgpr_write_b32 a167, 0
  v_accvgpr_write_b32 a174, 0
  v_accvgpr_write_b32 a175, 0
  v_accvgpr_write_b32 a182, 0
  v_accvgpr_write_b32 a183, 0
  v_accvgpr_write_b32 a190, 0
  v_accvgpr_write_b32 a191, 0
  v_accvgpr_write_b32 a198, 0
  v_accvgpr_write_b32 a199, 0
  v_accvgpr_write_b32 a206, 0
  v_accvgpr_write_b32 a207, 0
  v_accvgpr_write_b32 a214, 0
  v_accvgpr_write_b32 a215, 0
  v_accvgpr_write_b32 a222, 0
  v_accvgpr_write_b32 a223, 0
  v_accvgpr_write_b32 a230, 0
  v_accvgpr_write_b32 a231, 0
  v_accvgpr_write_b32 a238, 0
  v_accvgpr_write_b32 a239, 0
  s_waitcnt lgkmcnt(4)
  v_accvgpr_write_b32 a246, 0
  v_accvgpr_write_b32 a247, 0
  s_waitcnt lgkmcnt(0)
  v_accvgpr_write_b32 a254, 0
  v_accvgpr_write_b32 a255, 0
  s_mov_b32 exec_lo, -1
  s_waitcnt lgkmcnt(0)
  s_barrier
wob_30:
  s_waitcnt vmcnt(7)
  v_mfma_f32_32x32x16_bf16 v[192:207], v[144:147], v[24:27], 0
  s_waitcnt vmcnt(6)
  v_mfma_f32_32x32x16_bf16 v[192:207], v[148:151], v[28:31], v[192:207]
  v_mfma_f32_32x32x16_bf16 v[208:223], v[144:147], v[32:35], 0
  v_mfma_f32_32x32x16_bf16 v[208:223], v[148:151], v[36:39], v[208:223]
  s_nop 9
  v_exp_f32 v192, v192
  v_exp_f32 v193, v193
  v_exp_f32 v194, v194
  v_exp_f32 v195, v195
  s_waitcnt vmcnt(4)
.p2align 3
attn_loop:
  v_exp_f32 v196, v196
  v_exp_f32 v197, v197
  v_exp_f32 v198, v198
  v_exp_f32 v199, v199
  v_mfma_f32_32x32x16_bf16 v[176:191], v[144:147], v[40:43], 0
  v_exp_f32 v200, v200
  v_exp_f32 v201, v201
  v_exp_f32 v202, v202
  v_exp_f32 v203, v203
  v_smfmac_f32_32x32x32_bf16 v[64:79], v[152:155], v[192:199], v248
  global_load_dwordx4 v[128:131], v1, s[14:15] offset:0 sc1
  global_load_dwordx4 v[132:135], v1, s[14:15] offset:1024 sc1
  global_load_dwordx4 v[136:139], v1, s[14:15] offset:2048 sc1
  global_load_dwordx4 v[140:143], v1, s[14:15] offset:3072 sc1
  v_exp_f32 v204, v204
  v_exp_f32 v205, v205
  v_exp_f32 v206, v206
  v_exp_f32 v207, v207
  v_mfma_f32_32x32x16_bf16 v[176:191], v[148:151], v[44:47], v[176:191]
  s_add_u32 s13, s13, 1
  v_exp_f32 v208, v208
  v_exp_f32 v209, v209
  v_exp_f32 v210, v210
  v_exp_f32 v211, v211
  v_smfmac_f32_32x32x32_bf16 v[64:79], v[156:159], v[200:207], v248
  s_cmp_eq_u32 s13, s16
  v_exp_f32 v212, v212
  v_exp_f32 v213, v213
  v_exp_f32 v214, v214
  v_exp_f32 v215, v215
  v_mfma_f32_32x32x16_bf16 v[192:207], v[144:147], v[16:19], 0
  s_cselect_b32 s18, s19, s24
  v_exp_f32 v216, v216
  v_exp_f32 v217, v217
  v_exp_f32 v218, v218
  v_exp_f32 v219, v219
  v_smfmac_f32_32x32x32_bf16 v[80:95], v[152:155], v[208:215], v248
  s_add_u32 s14, s14, s18
  v_exp_f32 v220, v220
  v_exp_f32 v221, v221
  v_exp_f32 v222, v222
  v_exp_f32 v223, v223
  v_mfma_f32_32x32x16_bf16 v[192:207], v[148:151], v[20:23], v[192:207]
  s_addc_u32 s15, s15, 0
  v_exp_f32 v176, v176
  v_exp_f32 v177, v177
  v_exp_f32 v178, v178
  v_exp_f32 v179, v179
  v_smfmac_f32_32x32x32_bf16 v[80:95], v[156:159], v[216:223], v248
  s_waitcnt vmcnt(4)
  v_exp_f32 v180, v180
  v_exp_f32 v181, v181
  v_exp_f32 v182, v182
  v_exp_f32 v183, v183
  v_mfma_f32_32x32x16_bf16 v[208:223], v[160:163], v[24:27], 0
  v_exp_f32 v184, v184
  v_exp_f32 v185, v185
  v_exp_f32 v186, v186
  v_exp_f32 v187, v187
  v_smfmac_f32_32x32x32_bf16 v[96:111], v[152:155], v[176:183], v248
  v_exp_f32 v188, v188
  v_exp_f32 v189, v189
  v_exp_f32 v190, v190
  v_exp_f32 v191, v191
  v_mfma_f32_32x32x16_bf16 v[208:223], v[164:167], v[28:31], v[208:223]
  s_mov_b32 m0, s61
  v_exp_f32 v192, v192
  v_exp_f32 v193, v193
  v_exp_f32 v194, v194
  v_exp_f32 v195, v195
  v_smfmac_f32_32x32x32_bf16 v[96:111], v[156:159], v[184:191], v248
  buffer_load_dwordx4 v1, s[8:11], s60 offen offset:1024 sc1 lds
  buffer_load_dwordx4 v1, s[8:11], s60 offen offset:2048 sc1 lds
  v_exp_f32 v196, v196
  v_exp_f32 v197, v197
  v_exp_f32 v198, v198
  v_exp_f32 v199, v199
  v_mfma_f32_32x32x16_bf16 v[176:191], v[160:163], v[32:35], 0
  s_add_u32 s60, s60, 3072
  v_exp_f32 v200, v200
  v_exp_f32 v201, v201
  v_exp_f32 v202, v202
  v_exp_f32 v203, v203
  v_smfmac_f32_32x32x32_bf16 v[48:63], v[152:155], v[192:199], v248
  s_add_u32 s61, s61, 3072
  v_exp_f32 v204, v204
  v_exp_f32 v205, v205
  v_exp_f32 v206, v206
  v_exp_f32 v207, v207
  v_mfma_f32_32x32x16_bf16 v[176:191], v[164:167], v[36:39], v[176:191]
  v_exp_f32 v208, v208
  v_exp_f32 v209, v209
  v_exp_f32 v210, v210
  v_exp_f32 v211, v211
  v_smfmac_f32_32x32x32_bf16 v[48:63], v[156:159], v[200:207], v248
  v_exp_f32 v212, v212
  v_exp_f32 v213, v213
  v_exp_f32 v214, v214
  v_exp_f32 v215, v215
  v_mfma_f32_32x32x16_bf16 v[192:207], v[160:163], v[40:43], 0
  v_exp_f32 v216, v216
  v_exp_f32 v217, v217
  v_exp_f32 v218, v218
  v_exp_f32 v219, v219
  v_smfmac_f32_32x32x32_bf16 v[64:79], v[168:171], v[208:215], v248
  global_load_dwordx4 v[144:147], v1, s[14:15] offset:0 sc1
  global_load_dwordx4 v[148:151], v1, s[14:15] offset:1024 sc1
  global_load_dwordx4 v[152:155], v1, s[14:15] offset:2048 sc1
  global_load_dwordx4 v[156:159], v1, s[14:15] offset:3072 sc1
  v_exp_f32 v220, v220
  v_exp_f32 v221, v221
  v_exp_f32 v222, v222
  v_exp_f32 v223, v223
  v_mfma_f32_32x32x16_bf16 v[192:207], v[164:167], v[44:47], v[192:207]
  s_add_u32 s13, s13, 1
  v_exp_f32 v176, v176
  v_exp_f32 v177, v177
  v_exp_f32 v178, v178
  v_exp_f32 v179, v179
  v_smfmac_f32_32x32x32_bf16 v[64:79], v[172:175], v[216:223], v248
  s_cmp_eq_u32 s13, s16
  v_exp_f32 v180, v180
  v_exp_f32 v181, v181
  v_exp_f32 v182, v182
  v_exp_f32 v183, v183
  v_mfma_f32_32x32x16_bf16 v[208:223], v[160:163], v[16:19], 0
  s_cselect_b32 s18, s19, s24
  v_exp_f32 v184, v184
  v_exp_f32 v185, v185
  v_exp_f32 v186, v186
  v_exp_f32 v187, v187
  v_smfmac_f32_32x32x32_bf16 v[80:95], v[168:171], v[176:183], v248
  s_add_u32 s14, s14, s18
  v_exp_f32 v188, v188
  v_exp_f32 v189, v189
  v_exp_f32 v190, v190
  v_exp_f32 v191, v191
  v_mfma_f32_32x32x16_bf16 v[208:223], v[164:167], v[20:23], v[208:223]
  s_addc_u32 s15, s15, 0
  v_exp_f32 v192, v192
  v_exp_f32 v193, v193
  v_exp_f32 v194, v194
  v_exp_f32 v195, v195
  v_smfmac_f32_32x32x32_bf16 v[80:95], v[172:175], v[184:191], v248
  s_waitcnt vmcnt(6)
  v_exp_f32 v196, v196
  v_exp_f32 v197, v197
  v_exp_f32 v198, v198
  v_exp_f32 v199, v199
  v_mfma_f32_32x32x16_bf16 v[176:191], v[128:131], v[24:27], 0
  v_exp_f32 v200, v200
  v_exp_f32 v201, v201
  v_exp_f32 v202, v202
  v_exp_f32 v203, v203
  v_smfmac_f32_32x32x32_bf16 v[96:111], v[168:171], v[192:199], v248
  v_exp_f32 v204, v204
  v_exp_f32 v205, v205
  v_exp_f32 v206, v206
  v_exp_f32 v207, v207
  v_mfma_f32_32x32x16_bf16 v[176:191], v[132:135], v[28:31], v[176:191]
  v_exp_f32 v208, v208
  v_exp_f32 v209, v209
  v_exp_f32 v210, v210
  v_exp_f32 v211, v211
  v_smfmac_f32_32x32x32_bf16 v[96:111], v[172:175], v[200:207], v248
  v_exp_f32 v212, v212
  v_exp_f32 v213, v213
  v_exp_f32 v214, v214
  v_exp_f32 v215, v215
  v_mfma_f32_32x32x16_bf16 v[192:207], v[128:131], v[32:35], 0
  v_exp_f32 v216, v216
  v_exp_f32 v217, v217
  v_exp_f32 v218, v218
  v_exp_f32 v219, v219
  v_smfmac_f32_32x32x32_bf16 v[48:63], v[168:171], v[208:215], v248
  v_exp_f32 v220, v220
  v_exp_f32 v221, v221
  v_exp_f32 v222, v222
  v_exp_f32 v223, v223
  v_mfma_f32_32x32x16_bf16 v[192:207], v[132:135], v[36:39], v[192:207]
  v_exp_f32 v176, v176
  v_exp_f32 v177, v177
  v_exp_f32 v178, v178
  v_exp_f32 v179, v179
  v_smfmac_f32_32x32x32_bf16 v[48:63], v[172:175], v[216:223], v248
  v_exp_f32 v180, v180
  v_exp_f32 v181, v181
  v_exp_f32 v182, v182
  v_exp_f32 v183, v183
  v_mfma_f32_32x32x16_bf16 v[208:223], v[128:131], v[40:43], 0
  v_exp_f32 v184, v184
  v_exp_f32 v185, v185
  v_exp_f32 v186, v186
  v_exp_f32 v187, v187
  v_smfmac_f32_32x32x32_bf16 v[64:79], v[136:139], v[176:183], v248
  global_load_dwordx4 v[160:163], v1, s[14:15] offset:0 sc1
  global_load_dwordx4 v[164:167], v1, s[14:15] offset:1024 sc1
  global_load_dwordx4 v[168:171], v1, s[14:15] offset:2048 sc1
  global_load_dwordx4 v[172:175], v1, s[14:15] offset:3072 sc1
  v_exp_f32 v188, v188
  v_exp_f32 v189, v189
  v_exp_f32 v190, v190
  v_exp_f32 v191, v191
  v_mfma_f32_32x32x16_bf16 v[208:223], v[132:135], v[44:47], v[208:223]
  s_add_u32 s13, s13, 1
  v_exp_f32 v192, v192
  v_exp_f32 v193, v193
  v_exp_f32 v194, v194
  v_exp_f32 v195, v195
  v_smfmac_f32_32x32x32_bf16 v[64:79], v[140:143], v[184:191], v248
  s_cmp_eq_u32 s13, s16
  v_exp_f32 v196, v196
  v_exp_f32 v197, v197
  v_exp_f32 v198, v198
  v_exp_f32 v199, v199
  v_mfma_f32_32x32x16_bf16 v[176:191], v[128:131], v[16:19], 0
  s_cselect_b32 s18, s19, s24
  v_exp_f32 v200, v200
  v_exp_f32 v201, v201
  v_exp_f32 v202, v202
  v_exp_f32 v203, v203
  v_smfmac_f32_32x32x32_bf16 v[80:95], v[136:139], v[192:199], v248
  s_add_u32 s14, s14, s18
  v_exp_f32 v204, v204
  v_exp_f32 v205, v205
  v_exp_f32 v206, v206
  v_exp_f32 v207, v207
  v_mfma_f32_32x32x16_bf16 v[176:191], v[132:135], v[20:23], v[176:191]
  s_addc_u32 s15, s15, 0
  v_exp_f32 v208, v208
  v_exp_f32 v209, v209
  v_exp_f32 v210, v210
  v_exp_f32 v211, v211
  v_smfmac_f32_32x32x32_bf16 v[80:95], v[140:143], v[200:207], v248
  s_waitcnt vmcnt(4)
  v_exp_f32 v212, v212
  v_exp_f32 v213, v213
  v_exp_f32 v214, v214
  v_exp_f32 v215, v215
  v_mfma_f32_32x32x16_bf16 v[192:207], v[144:147], v[24:27], 0
  v_exp_f32 v216, v216
  v_exp_f32 v217, v217
  v_exp_f32 v218, v218
  v_exp_f32 v219, v219
  v_smfmac_f32_32x32x32_bf16 v[96:111], v[136:139], v[208:215], v248
  v_exp_f32 v220, v220
  v_exp_f32 v221, v221
  v_exp_f32 v222, v222
  v_exp_f32 v223, v223
  v_mfma_f32_32x32x16_bf16 v[192:207], v[148:151], v[28:31], v[192:207]
  v_exp_f32 v176, v176
  v_exp_f32 v177, v177
  v_exp_f32 v178, v178
  v_exp_f32 v179, v179
  v_smfmac_f32_32x32x32_bf16 v[96:111], v[140:143], v[216:223], v248
  v_exp_f32 v180, v180
  v_exp_f32 v181, v181
  v_exp_f32 v182, v182
  v_exp_f32 v183, v183
  v_mfma_f32_32x32x16_bf16 v[208:223], v[144:147], v[32:35], 0
  v_exp_f32 v184, v184
  v_exp_f32 v185, v185
  v_exp_f32 v186, v186
  v_exp_f32 v187, v187
  v_smfmac_f32_32x32x32_bf16 v[48:63], v[136:139], v[176:183], v248
  s_sub_u32 s17, s17, 1
  v_exp_f32 v188, v188
  v_exp_f32 v189, v189
  v_exp_f32 v190, v190
  v_exp_f32 v191, v191
  v_mfma_f32_32x32x16_bf16 v[208:223], v[148:151], v[36:39], v[208:223]
  s_cmp_lg_u32 s17, 0
  v_exp_f32 v192, v192
  v_exp_f32 v193, v193
  v_exp_f32 v194, v194
  v_exp_f32 v195, v195
  v_smfmac_f32_32x32x32_bf16 v[48:63], v[140:143], v[184:191], v248
  s_cbranch_scc1 attn_loop
  v_exp_f32 v196, v196
  v_exp_f32 v197, v197
  v_exp_f32 v198, v198
  v_exp_f32 v199, v199
  v_mfma_f32_32x32x16_bf16 v[176:191], v[144:147], v[40:43], 0
  v_exp_f32 v200, v200
  v_exp_f32 v201, v201
  v_exp_f32 v202, v202
  v_exp_f32 v203, v203
  v_smfmac_f32_32x32x32_bf16 v[64:79], v[152:155], v[192:199], v248
  global_load_dwordx4 v[128:131], v1, s[14:15] offset:0 sc1
  global_load_dwordx4 v[132:135], v1, s[14:15] offset:1024 sc1
  global_load_dwordx4 v[136:139], v1, s[14:15] offset:2048 sc1
  global_load_dwordx4 v[140:143], v1, s[14:15] offset:3072 sc1
  v_exp_f32 v204, v204
  v_exp_f32 v205, v205
  v_exp_f32 v206, v206
  v_exp_f32 v207, v207
  v_mfma_f32_32x32x16_bf16 v[176:191], v[148:151], v[44:47], v[176:191]
  s_add_u32 s13, s13, 1
  v_exp_f32 v208, v208
  v_exp_f32 v209, v209
  v_exp_f32 v210, v210
  v_exp_f32 v211, v211
  v_smfmac_f32_32x32x32_bf16 v[64:79], v[156:159], v[200:207], v248
  s_cmp_eq_u32 s13, s16
  v_exp_f32 v212, v212
  v_exp_f32 v213, v213
  v_exp_f32 v214, v214
  v_exp_f32 v215, v215
  v_mfma_f32_32x32x16_bf16 v[192:207], v[144:147], v[16:19], 0
  s_cselect_b32 s18, s19, s24
  v_exp_f32 v216, v216
  v_exp_f32 v217, v217
  v_exp_f32 v218, v218
  v_exp_f32 v219, v219
  v_smfmac_f32_32x32x32_bf16 v[80:95], v[152:155], v[208:215], v248
  s_add_u32 s14, s14, s18
  v_exp_f32 v220, v220
  v_exp_f32 v221, v221
  v_exp_f32 v222, v222
  v_exp_f32 v223, v223
  v_mfma_f32_32x32x16_bf16 v[192:207], v[148:151], v[20:23], v[192:207]
  s_addc_u32 s15, s15, 0
  v_exp_f32 v176, v176
  v_exp_f32 v177, v177
  v_exp_f32 v178, v178
  v_exp_f32 v179, v179
  v_smfmac_f32_32x32x32_bf16 v[80:95], v[156:159], v[216:223], v248
  s_waitcnt vmcnt(4)
  v_exp_f32 v180, v180
  v_exp_f32 v181, v181
  v_exp_f32 v182, v182
  v_exp_f32 v183, v183
  v_mfma_f32_32x32x16_bf16 v[208:223], v[160:163], v[24:27], 0
  v_exp_f32 v184, v184
  v_exp_f32 v185, v185
  v_exp_f32 v186, v186
  v_exp_f32 v187, v187
  v_smfmac_f32_32x32x32_bf16 v[96:111], v[152:155], v[176:183], v248
  v_exp_f32 v188, v188
  v_exp_f32 v189, v189
  v_exp_f32 v190, v190
  v_exp_f32 v191, v191
  v_mfma_f32_32x32x16_bf16 v[208:223], v[164:167], v[28:31], v[208:223]
  s_mov_b32 m0, s61
  v_exp_f32 v192, v192
  v_exp_f32 v193, v193
  v_exp_f32 v194, v194
  v_exp_f32 v195, v195
  v_smfmac_f32_32x32x32_bf16 v[96:111], v[156:159], v[184:191], v248
  buffer_load_dwordx4 v1, s[8:11], s60 offen offset:1024 sc1 lds
  buffer_load_dwordx4 v1, s[8:11], s60 offen offset:2048 sc1 lds
  v_exp_f32 v196, v196
  v_exp_f32 v197, v197
  v_exp_f32 v198, v198
  v_exp_f32 v199, v199
  v_mfma_f32_32x32x16_bf16 v[176:191], v[160:163], v[32:35], 0
  s_add_u32 s60, s60, 3072
  v_exp_f32 v200, v200
  v_exp_f32 v201, v201
  v_exp_f32 v202, v202
  v_exp_f32 v203, v203
  v_smfmac_f32_32x32x32_bf16 v[48:63], v[152:155], v[192:199], v248
  s_add_u32 s61, s61, 3072
  v_exp_f32 v204, v204
  v_exp_f32 v205, v205
  v_exp_f32 v206, v206
  v_exp_f32 v207, v207
  v_mfma_f32_32x32x16_bf16 v[176:191], v[164:167], v[36:39], v[176:191]
  v_exp_f32 v208, v208
  v_exp_f32 v209, v209
  v_exp_f32 v210, v210
  v_exp_f32 v211, v211
  v_smfmac_f32_32x32x32_bf16 v[48:63], v[156:159], v[200:207], v248
  v_exp_f32 v212, v212
  v_exp_f32 v213, v213
  v_exp_f32 v214, v214
  v_exp_f32 v215, v215
  v_mfma_f32_32x32x16_bf16 v[192:207], v[160:163], v[40:43], 0
  s_mov_b32 m0, s61
  v_exp_f32 v216, v216
  v_exp_f32 v217, v217
  v_exp_f32 v218, v218
  v_exp_f32 v219, v219
  v_smfmac_f32_32x32x32_bf16 v[64:79], v[168:171], v[208:215], v248
  buffer_load_dwordx4 v1, s[8:11], s60 offen offset:1024 sc1 lds
  buffer_load_dwordx4 v1, s[8:11], s60 offen offset:2048 sc1 lds
  v_exp_f32 v220, v220
  v_exp_f32 v221, v221
  v_exp_f32 v222, v222
  v_exp_f32 v223, v223
  v_mfma_f32_32x32x16_bf16 v[192:207], v[164:167], v[44:47], v[192:207]
  s_add_u32 s60, s60, 3072
  v_exp_f32 v176, v176
  v_exp_f32 v177, v177
  v_exp_f32 v178, v178
  v_exp_f32 v179, v179
  v_smfmac_f32_32x32x32_bf16 v[64:79], v[172:175], v[216:223], v248
  buffer_load_dword v255, v250, s[8:11], s87 offen sc1
  buffer_load_dword v255, v250, s[8:11], s88 offen sc1
  s_mov_b64 exec, 0xff
  buffer_load_dword v255, v250, s[8:11], s89 offen sc1
  s_mov_b64 exec, -1
  v_exp_f32 v180, v180
  v_exp_f32 v181, v181
  v_exp_f32 v182, v182
  v_exp_f32 v183, v183
  v_mfma_f32_32x32x16_bf16 v[208:223], v[160:163], v[16:19], 0
  s_add_u32 s61, s61, 3072
  v_exp_f32 v184, v184
  v_exp_f32 v185, v185
  v_exp_f32 v186, v186
  v_exp_f32 v187, v187
  v_smfmac_f32_32x32x32_bf16 v[80:95], v[168:171], v[176:183], v248
  s_add_u32 s48, s84, 0
  buffer_load_dwordx4 v[224:227], v1, s[8:11], s48 offen sc1
  buffer_load_dwordx4 v[228:231], v1, s[8:11], s48 offen offset:1024 sc1
  v_exp_f32 v188, v188
  v_exp_f32 v189, v189
  v_exp_f32 v190, v190
  v_exp_f32 v191, v191
  v_mfma_f32_32x32x16_bf16 v[208:223], v[164:167], v[20:23], v[208:223]
  v_exp_f32 v192, v192
  v_exp_f32 v193, v193
  v_exp_f32 v194, v194
  v_exp_f32 v195, v195
  v_smfmac_f32_32x32x32_bf16 v[80:95], v[172:175], v[184:191], v248
  s_waitcnt vmcnt(9)
  v_exp_f32 v196, v196
  v_exp_f32 v197, v197
  v_exp_f32 v198, v198
  v_exp_f32 v199, v199
  v_mfma_f32_32x32x16_bf16 v[176:191], v[128:131], v[24:27], 0
  v_exp_f32 v200, v200
  v_exp_f32 v201, v201
  v_exp_f32 v202, v202
  v_exp_f32 v203, v203
  v_smfmac_f32_32x32x32_bf16 v[96:111], v[168:171], v[192:199], v248
  v_exp_f32 v204, v204
  v_exp_f32 v205, v205
  v_exp_f32 v206, v206
  v_exp_f32 v207, v207
  v_mfma_f32_32x32x16_bf16 v[176:191], v[132:135], v[28:31], v[176:191]
  s_mov_b32 m0, s61
  v_exp_f32 v208, v208
  v_exp_f32 v209, v209
  v_exp_f32 v210, v210
  v_exp_f32 v211, v211
  v_smfmac_f32_32x32x32_bf16 v[96:111], v[172:175], v[200:207], v248
  buffer_load_dwordx4 v1, s[8:11], s60 offen offset:1024 sc1 lds
  buffer_load_dwordx4 v1, s[8:11], s60 offen offset:2048 sc1 lds
  v_exp_f32 v212, v212
  v_exp_f32 v213, v213
  v_exp_f32 v214, v214
  v_exp_f32 v215, v215
  v_mfma_f32_32x32x16_bf16 v[192:207], v[128:131], v[32:35], 0
  s_add_u32 s60, s60, 3072
  v_exp_f32 v216, v216
  v_exp_f32 v217, v217
  v_exp_f32 v218, v218
  v_exp_f32 v219, v219
  v_smfmac_f32_32x32x32_bf16 v[48:63], v[168:171], v[208:215], v248
  s_add_u32 s61, s61, 3072
  v_exp_f32 v220, v220
  v_exp_f32 v221, v221
  v_exp_f32 v222, v222
  v_exp_f32 v223, v223
  v_mfma_f32_32x32x16_bf16 v[192:207], v[132:135], v[36:39], v[192:207]
  v_exp_f32 v176, v176
  v_exp_f32 v177, v177
  v_exp_f32 v178, v178
  v_exp_f32 v179, v179
  v_smfmac_f32_32x32x32_bf16 v[48:63], v[172:175], v[216:223], v248
  v_exp_f32 v180, v180
  v_exp_f32 v181, v181
  v_exp_f32 v182, v182
  v_exp_f32 v183, v183
  v_mfma_f32_32x32x16_bf16 v[208:223], v[128:131], v[40:43], 0
  v_exp_f32 v184, v184
  v_exp_f32 v185, v185
  v_exp_f32 v186, v186
  v_exp_f32 v187, v187
  v_smfmac_f32_32x32x32_bf16 v[64:79], v[136:139], v[176:183], v248
  v_exp_f32 v188, v188
  v_exp_f32 v189, v189
  v_exp_f32 v190, v190
  v_exp_f32 v191, v191
  v_mfma_f32_32x32x16_bf16 v[208:223], v[132:135], v[44:47], v[208:223]
  v_exp_f32 v192, v192
  v_exp_f32 v193, v193
  v_exp_f32 v194, v194
  v_exp_f32 v195, v195
  v_smfmac_f32_32x32x32_bf16 v[64:79], v[140:143], v[184:191], v248
  v_exp_f32 v196, v196
  v_exp_f32 v197, v197
  v_exp_f32 v198, v198
  v_exp_f32 v199, v199
  v_mfma_f32_32x32x16_bf16 v[176:191], v[128:131], v[16:19], 0
  v_exp_f32 v200, v200
  v_exp_f32 v201, v201
  v_exp_f32 v202, v202
  v_exp_f32 v203, v203
  v_smfmac_f32_32x32x32_bf16 v[80:95], v[136:139], v[192:199], v248
  v_exp_f32 v204, v204
  v_exp_f32 v205, v205
  v_exp_f32 v206, v206
  v_exp_f32 v207, v207
  v_mfma_f32_32x32x16_bf16 v[176:191], v[132:135], v[20:23], v[176:191]
  ds_write_b128 v116, v[64:67] offset:0
  v_exp_f32 v208, v208
  v_exp_f32 v209, v209
  v_exp_f32 v210, v210
  v_exp_f32 v211, v211
  v_smfmac_f32_32x32x32_bf16 v[80:95], v[140:143], v[200:207], v248
  ds_write_b128 v116, v[68:71] offset:1024
  v_exp_f32 v212, v212
  v_exp_f32 v213, v213
  v_exp_f32 v214, v214
  v_exp_f32 v215, v215
  ds_write_b128 v116, v[72:75] offset:2048
  v_exp_f32 v216, v216
  v_exp_f32 v217, v217
  v_exp_f32 v218, v218
  v_exp_f32 v219, v219
  v_smfmac_f32_32x32x32_bf16 v[96:111], v[136:139], v[208:215], v248
  ds_write_b128 v116, v[76:79] offset:3072
  v_exp_f32 v220, v220
  v_exp_f32 v221, v221
  v_exp_f32 v222, v222
  v_exp_f32 v223, v223
  ds_write_b128 v117, v[80:83] offset:0
  v_exp_f32 v176, v176
  v_exp_f32 v177, v177
  v_exp_f32 v178, v178
  v_exp_f32 v179, v179
  v_smfmac_f32_32x32x32_bf16 v[96:111], v[140:143], v[216:223], v248
  ds_write_b128 v117, v[84:87] offset:1024
  ds_write_b128 v117, v[88:91] offset:2048
  v_exp_f32 v180, v180
  v_exp_f32 v181, v181
  v_exp_f32 v182, v182
  v_exp_f32 v183, v183
  ds_write_b128 v117, v[92:95] offset:3072
  v_exp_f32 v184, v184
  v_exp_f32 v185, v185
  v_exp_f32 v186, v186
  v_exp_f32 v187, v187
  v_smfmac_f32_32x32x32_bf16 v[48:63], v[136:139], v[176:183], v248
  v_exp_f32 v188, v188
  v_exp_f32 v189, v189
  v_exp_f32 v190, v190
  v_exp_f32 v191, v191
  ds_write_b128 v118, v[96:99] offset:0
  ds_write_b128 v118, v[100:103] offset:1024
  ds_write_b128 v118, v[104:107] offset:2048
  ds_write_b128 v118, v[108:111] offset:3072
  v_smfmac_f32_32x32x32_bf16 v[48:63], v[140:143], v[184:191], v248
  s_waitcnt lgkmcnt(0)
  s_barrier
  ds_read_b128 v[64:67], v115 offset:0
  ds_read_b128 v[68:71], v115 offset:1024
  ds_read_b128 v[72:75], v115 offset:2048
  ds_read_b128 v[76:79], v115 offset:3072
  ds_read_b128 v[80:83], v115 offset:4096
  ds_read_b128 v[84:87], v115 offset:5120
  ds_read_b128 v[88:91], v115 offset:6144
  ds_read_b128 v[92:95], v115 offset:7168
  ds_read_b128 v[96:99], v115 offset:8192
  ds_read_b128 v[100:103], v115 offset:9216
  ds_read_b128 v[104:107], v115 offset:10240
  ds_read_b128 v[108:111], v115 offset:11264
  s_waitcnt lgkmcnt(11)
  v_pk_add_f32 v[48:49], v[48:49], v[64:65]
  v_pk_add_f32 v[50:51], v[50:51], v[66:67]
  s_waitcnt lgkmcnt(10)
  v_pk_add_f32 v[52:53], v[52:53], v[68:69]
  v_pk_add_f32 v[54:55], v[54:55], v[70:71]
  s_waitcnt lgkmcnt(9)
  v_pk_add_f32 v[56:57], v[56:57], v[72:73]
  v_pk_add_f32 v[58:59], v[58:59], v[74:75]
  s_waitcnt lgkmcnt(8)
  v_pk_add_f32 v[60:61], v[60:61], v[76:77]
  v_pk_add_f32 v[62:63], v[62:63], v[78:79]
  s_waitcnt lgkmcnt(7)
  v_pk_add_f32 v[48:49], v[48:49], v[80:81]
  v_pk_add_f32 v[50:51], v[50:51], v[82:83]
  s_waitcnt lgkmcnt(6)
  v_pk_add_f32 v[52:53], v[52:53], v[84:85]
  v_pk_add_f32 v[54:55], v[54:55], v[86:87]
  s_waitcnt lgkmcnt(5)
  v_pk_add_f32 v[56:57], v[56:57], v[88:89]
  v_pk_add_f32 v[58:59], v[58:59], v[90:91]
  s_waitcnt lgkmcnt(4)
  v_pk_add_f32 v[60:61], v[60:61], v[92:93]
  v_pk_add_f32 v[62:63], v[62:63], v[94:95]
  s_waitcnt lgkmcnt(3)
  v_pk_add_f32 v[48:49], v[48:49], v[96:97]
  v_pk_add_f32 v[50:51], v[50:51], v[98:99]
  s_waitcnt lgkmcnt(2)
  v_pk_add_f32 v[52:53], v[52:53], v[100:101]
  v_pk_add_f32 v[54:55], v[54:55], v[102:103]
  s_waitcnt lgkmcnt(1)
  v_pk_add_f32 v[56:57], v[56:57], v[104:105]
  v_pk_add_f32 v[58:59], v[58:59], v[106:107]
  s_waitcnt lgkmcnt(0)
  v_pk_add_f32 v[60:61], v[60:61], v[108:109]
  v_pk_add_f32 v[62:63], v[62:63], v[110:111]
  v_mov_b32 v112, v60
  v_mov_b32 v113, v60
  s_nop 1
  v_permlane32_swap_b32 v113, v112
  v_cmp_le_f32 vcc, s20, v112
  v_cmp_ge_f32 s[22:23], s21, v112
  s_nop 0
  s_and_b64 vcc, vcc, s[22:23]
  s_cmp_eq_u64 vcc, exec
  s_cbranch_scc0 attn_slow
attn_fin:
  v_rcp_f32 v112, v112
  s_nop 0
  v_pk_mul_f32 v[48:49], v[48:49], v[112:113] op_sel_hi:[1,0]
  v_cvt_pk_bf16_f32 v176, v48, v49
  v_pk_mul_f32 v[50:51], v[50:51], v[112:113] op_sel_hi:[1,0]
  v_cvt_pk_bf16_f32 v177, v50, v51
  v_pk_mul_f32 v[52:53], v[52:53], v[112:113] op_sel_hi:[1,0]
  v_cvt_pk_bf16_f32 v178, v52, v53
  v_pk_mul_f32 v[54:55], v[54:55], v[112:113] op_sel_hi:[1,0]
  v_cvt_pk_bf16_f32 v179, v54, v55
  v_pk_mul_f32 v[56:57], v[56:57], v[112:113] op_sel_hi:[1,0]
  v_cvt_pk_bf16_f32 v180, v56, v57
  v_pk_mul_f32 v[58:59], v[58:59], v[112:113] op_sel_hi:[1,0]
  v_cvt_pk_bf16_f32 v181, v58, v59
  v_pk_mul_f32 v[60:61], v[60:61], v[112:113] op_sel_hi:[1,0]
  v_cvt_pk_bf16_f32 v182, v60, v61
  v_pk_mul_f32 v[62:63], v[62:63], v[112:113] op_sel_hi:[1,0]
  v_cvt_pk_bf16_f32 v183, v62, v63
  s_cmp_lg_u32 s44, 0
  s_cbranch_scc1 ls_31
  buffer_store_dwordx4 v[176:179], v1, s[8:11], s51 offen sc1
  buffer_store_dwordx4 v[180:183], v1, s[8:11], s51 offen offset:1024 sc1
  s_branch ls_32
ls_31:
  buffer_store_dwordx4 v[176:179], v1, s[8:11], s51 offen
  buffer_store_dwordx4 v[180:183], v1, s[8:11], s51 offen offset:1024
ls_32:
  s_waitcnt vmcnt(5)
  v_lshlrev_b32 v112, 16, v224
  v_and_b32 v113, 0xffff0000, v224
  v_lshlrev_b32 v114, 16, v225
  v_and_b32 v115, 0xffff0000, v225
  v_lshlrev_b32 v116, 16, v226
  v_and_b32 v117, 0xffff0000, v226
  v_lshlrev_b32 v118, 16, v227
  v_and_b32 v119, 0xffff0000, v227
  s_waitcnt vmcnt(4)
  v_lshlrev_b32 v120, 16, v228
  v_and_b32 v121, 0xffff0000, v228
  v_lshlrev_b32 v122, 16, v229
  v_and_b32 v123, 0xffff0000, v229
  v_lshlrev_b32 v124, 16, v230
  v_and_b32 v125, 0xffff0000, v230
  v_lshlrev_b32 v126, 16, v231
  v_and_b32 v127, 0xffff0000, v231
  s_lshl_b32 s48, s4, 14
  s_and_b32 s48, s48, 0x8000
  s_add_u32 s48, s48, 86016
  v_add_u32 v236, s48, v1
  v_lshlrev_b32 v239, 3, v2
  v_lshl_add_u32 v239, v3, 2, v239
  s_lshr_b32 s50, s42, 1
  s_lshr_b32 s48, s50, 1
  s_and_b32 s49, s50, 1
  s_lshl_b32 s49, s49, 3
  s_add_u32 s48, s48, s49
  v_add_u32 v4, s48, v1
  v_lshlrev_b32 v4, 7, v4
  v_add_u32 v4, 15499264, v4
  s_waitcnt vmcnt(0) lgkmcnt(0)
  s_barrier
  s_cmp_lg_u32 s4, 0
  s_cbranch_scc1 sig_33
  s_add_u32 s48, s62, 1
  v_mov_b32 v244, s48
  v_mov_b32 v246, 0
  s_mov_b64 exec, 1
  s_add_u32 s48, s46, 32768
  s_cmp_lg_u32 s44, 0
  s_cbranch_scc1 ls_34
  buffer_store_dword v244, v246, s[8:11], s48 offen sc1
  s_branch ls_35
ls_34:
  buffer_store_dword v244, v246, s[8:11], s48 offen
ls_35:
  s_mov_b64 exec, -1
  s_nop 1
sig_33:
  s_add_u32 s62, s62, 1
  s_cmp_ge_u32 s43, 7
  s_cbranch_scc1 op_skip_37
  s_mov_b64 exec, 65535
  s_mov_b32 s48, 400000
  s_waitcnt lgkmcnt(0)
poll_38:
  buffer_load_dword v6, v4, s[8:11], 0 offen sc1
  s_sub_u32 s48, s48, 1
  s_cbranch_scc1 k_end
  s_waitcnt vmcnt(0)
  v_cmp_le_u32 vcc, s62, v6
  s_nop 0
  s_cmp_eq_u64 vcc, exec
  s_cbranch_scc0 poll_38
  s_mov_b64 exec, -1
  s_add_u32 m0, s92, 0
  s_add_u32 s17, s94, 2097152
  buffer_load_dwordx4 v1, s[8:11], s17 offen offset:0 sc1 lds
  buffer_load_dwordx4 v1, s[8:11], s17 offen offset:1024 sc1 lds
  s_add_u32 m0, s91, 4096
  s_add_u32 s17, s93, 2101248
  buffer_load_dwordx4 v1, s[8:11], s17 offen offset:0 sc1 lds
  buffer_load_dwordx4 v1, s[8:11], s17 offen offset:1024 sc1 lds
  buffer_load_dwordx4 v1, s[8:11], s17 offen offset:2048 sc1 lds
  buffer_load_dwordx4 v1, s[8:11], s17 offen offset:3072 sc1 lds
  s_add_u32 m0, s91, 12288
  s_add_u32 s17, s93, 2109440
  buffer_load_dwordx4 v1, s[8:11], s17 offen offset:0 sc1 lds
  buffer_load_dwordx4 v1, s[8:11], s17 offen offset:1024 sc1 lds
  buffer_load_dwordx4 v1, s[8:11], s17 offen offset:2048 sc1 lds
  buffer_load_dwordx4 v1, s[8:11], s17 offen offset:3072 sc1 lds
  s_add_u32 s51, s84, 0
  s_add_u32 s52, s85, 1835008
  s_mov_b32 s19, 1065369472
  s_waitcnt vmcnt(8)
  s_barrier
  ds_read_b128 v[32:35], v236 offset:0
  ds_read_b128 v[36:39], v236 offset:1024
  ds_read_b128 v[40:43], v236 offset:2048
  ds_read_b128 v[44:47], v236 offset:3072
  s_add_u32 m0, s91, 20480
  s_add_u32 s17, s93, 2117632
  buffer_load_dwordx4 v1, s[8:11], s17 offen offset:0 sc1 lds
  buffer_load_dwordx4 v1, s[8:11], s17 offen offset:1024 sc1 lds
  buffer_load_dwordx4 v1, s[8:11], s17 offen offset:2048 sc1 lds
  buffer_load_dwordx4 v1, s[8:11], s17 offen offset:3072 sc1 lds
  s_waitcnt lgkmcnt(3)
  v_mfma_f32_32x32x16_bf16 v[112:127], a[128:131], v[32:35], v[112:127]
  s_waitcnt lgkmcnt(2)
  v_mfma_f32_32x32x16_bf16 v[112:127], a[132:135], v[36:39], v[112:127]
  s_waitcnt vmcnt(8)
  s_barrier
  ds_read_b128 v[64:67], v236 offset:4096
  ds_read_b128 v[68:71], v236 offset:5120
  ds_read_b128 v[72:75], v236 offset:6144
  ds_read_b128 v[76:79], v236 offset:7168
  ds_read_b128 v[80:83], v236 offset:8192
  ds_read_b128 v[84:87], v236 offset:9216
  ds_read_b128 v[88:91], v236 offset:10240
  ds_read_b128 v[92:95], v236 offset:11264
  s_waitcnt lgkmcnt(9)
  v_mfma_f32_32x32x16_bf16 v[112:127], a[136:139], v[40:43], v[112:127]
  s_waitcnt lgkmcnt(8)
  v_mfma_f32_32x32x16_bf16 v[112:127], a[140:143], v[44:47], v[112:127]
  s_waitcnt lgkmcnt(7)
  v_mfma_f32_32x32x16_bf16 v[112:127], a[144:147], v[64:67], v[112:127]
  s_add_u32 m0, s92, 28672
  s_add_u32 s17, s94, 2125824
  buffer_load_dwordx4 v1, s[8:11], s17 offen offset:0 sc1 lds
  buffer_load_dwordx4 v1, s[8:11], s17 offen offset:1024 sc1 lds
  s_waitcnt lgkmcnt(6)
  v_mfma_f32_32x32x16_bf16 v[112:127], a[148:151], v[68:71], v[112:127]
  s_waitcnt lgkmcnt(5)
  v_mfma_f32_32x32x16_bf16 v[112:127], a[152:155], v[72:75], v[112:127]
  s_sub_u32 m0, s61, 21504
  s_sub_u32 s59, s60, 21504
  buffer_load_dwordx4 v1, s[8:11], s59 offen sc1 lds
  s_sub_u32 m0, s61, 18432
  s_sub_u32 s59, s60, 18432
  buffer_load_dwordx4 v1, s[8:11], s59 offen sc1 lds
  s_waitcnt lgkmcnt(4)
  v_mfma_f32_32x32x16_bf16 v[112:127], a[156:159], v[76:79], v[112:127]
  s_waitcnt lgkmcnt(3)
  v_mfma_f32_32x32x16_bf16 v[112:127], a[160:163], v[80:83], v[112:127]
  s_sub_u32 m0, s61, 15360
  s_sub_u32 s59, s60, 15360
  buffer_load_dwordx4 v1, s[8:11], s59 offen sc1 lds
  s_sub_u32 m0, s61, 12288
  s_sub_u32 s59, s60, 12288
  buffer_load_dwordx4 v1, s[8:11], s59 offen sc1 lds
  s_waitcnt lgkmcnt(2)
  v_mfma_f32_32x32x16_bf16 v[112:127], a[164:167], v[84:87], v[112:127]
  s_waitcnt vmcnt(10)
  s_barrier
  ds_read_b128 v[32:35], v236 offset:12288
  ds_read_b128 v[36:39], v236 offset:13312
  ds_read_b128 v[40:43], v236 offset:14336
  ds_read_b128 v[44:47], v236 offset:15360
  ds_read_b128 v[48:51], v236 offset:16384
  ds_read_b128 v[52:55], v236 offset:17408
  ds_read_b128 v[56:59], v236 offset:18432
  ds_read_b128 v[60:63], v236 offset:19456
  s_waitcnt lgkmcnt(9)
  v_mfma_f32_32x32x16_bf16 v[112:127], a[168:171], v[88:91], v[112:127]
  s_sub_u32 m0, s61, 9216
  s_sub_u32 s59, s60, 9216
  buffer_load_dwordx4 v1, s[8:11], s59 offen sc1 lds
  s_sub_u32 m0, s61, 6144
  s_sub_u32 s59, s60, 6144
  buffer_load_dwordx4 v1, s[8:11], s59 offen sc1 lds
  s_waitcnt lgkmcnt(8)
  v_mfma_f32_32x32x16_bf16 v[112:127], a[172:175], v[92:95], v[112:127]
  s_waitcnt lgkmcnt(7)
  v_mfma_f32_32x32x16_bf16 v[112:127], a[176:179], v[32:35], v[112:127]
  s_sub_u32 m0, s61, 3072
  s_sub_u32 s59, s60, 3072
  buffer_load_dwordx4 v1, s[8:11], s59 offen sc1 lds
  s_waitcnt lgkmcnt(6)
  v_mfma_f32_32x32x16_bf16 v[112:127], a[180:183], v[36:39], v[112:127]
  s_waitcnt lgkmcnt(5)
  v_mfma_f32_32x32x16_bf16 v[112:127], a[184:187], v[40:43], v[112:127]
  s_waitcnt lgkmcnt(4)
  v_mfma_f32_32x32x16_bf16 v[112:127], a[188:191], v[44:47], v[112:127]
  s_waitcnt lgkmcnt(3)
  v_mfma_f32_32x32x16_bf16 v[112:127], a[192:195], v[48:51], v[112:127]
  s_waitcnt lgkmcnt(2)
  v_mfma_f32_32x32x16_bf16 v[112:127], a[196:199], v[52:55], v[112:127]
  s_waitcnt vmcnt(9)
  s_barrier
  ds_read_b128 v[64:67], v236 offset:20480
  ds_read_b128 v[68:71], v236 offset:21504
  ds_read_b128 v[72:75], v236 offset:22528
  ds_read_b128 v[76:79], v236 offset:23552
  ds_read_b128 v[80:83], v236 offset:24576
  ds_read_b128 v[84:87], v236 offset:25600
  ds_read_b128 v[88:91], v236 offset:26624
  ds_read_b128 v[92:95], v236 offset:27648
  s_waitcnt lgkmcnt(9)
  v_mfma_f32_32x32x16_bf16 v[112:127], a[200:203], v[56:59], v[112:127]
  s_waitcnt lgkmcnt(8)
  v_mfma_f32_32x32x16_bf16 v[112:127], a[204:207], v[60:63], v[112:127]
  s_waitcnt lgkmcnt(7)
  v_mfma_f32_32x32x16_bf16 v[112:127], a[208:211], v[64:67], v[112:127]
  s_waitcnt lgkmcnt(6)
  v_mfma_f32_32x32x16_bf16 v[112:127], a[212:215], v[68:71], v[112:127]
  s_waitcnt lgkmcnt(5)
  v_mfma_f32_32x32x16_bf16 v[112:127], a[216:219], v[72:75], v[112:127]
  s_waitcnt lgkmcnt(4)
  v_mfma_f32_32x32x16_bf16 v[112:127], a[220:223], v[76:79], v[112:127]
  s_waitcnt lgkmcnt(3)
  v_mfma_f32_32x32x16_bf16 v[112:127], a[224:227], v[80:83], v[112:127]
  s_waitcnt lgkmcnt(2)
  v_mfma_f32_32x32x16_bf16 v[112:127], a[228:231], v[84:87], v[112:127]
  s_waitcnt vmcnt(7)
  s_barrier
  ds_read_b128 v[32:35], v236 offset:28672
  ds_read_b128 v[36:39], v236 offset:29696
  ds_read_b128 v[40:43], v236 offset:30720
  ds_read_b128 v[44:47], v236 offset:31744
  s_waitcnt lgkmcnt(5)
  v_mfma_f32_32x32x16_bf16 v[112:127], a[232:235], v[88:91], v[112:127]
  s_waitcnt lgkmcnt(4)
  v_mfma_f32_32x32x16_bf16 v[112:127], a[236:239], v[92:95], v[112:127]
  s_waitcnt lgkmcnt(3)
  v_mfma_f32_32x32x16_bf16 v[112:127], a[240:243], v[32:35], v[112:127]
  s_waitcnt lgkmcnt(2)
  v_mfma_f32_32x32x16_bf16 v[112:127], a[244:247], v[36:39], v[112:127]
  s_waitcnt lgkmcnt(1)
  v_mfma_f32_32x32x16_bf16 v[112:127], a[248:251], v[40:43], v[112:127]
  s_waitcnt lgkmcnt(0)
  v_mfma_f32_32x32x16_bf16 v[112:127], a[252:255], v[44:47], v[112:127]
  s_nop 11
  v_cvt_pk_bf16_f32 v224, v112, v113
  v_cvt_pk_bf16_f32 v225, v114, v115
  v_cvt_pk_bf16_f32 v226, v116, v117
  v_cvt_pk_bf16_f32 v227, v118, v119
  v_cvt_pk_bf16_f32 v228, v120, v121
  v_cvt_pk_bf16_f32 v229, v122, v123
  v_cvt_pk_bf16_f32 v230, v124, v125
  v_cvt_pk_bf16_f32 v231, v126, v127
  s_cmp_lg_u32 s63, 0
  s_cbranch_scc1 op_final
  s_cmp_lg_u32 s44, 0
  s_cbranch_scc1 ls_39
  buffer_store_dwordx4 v[224:227], v1, s[8:11], s51 offen sc1
  buffer_store_dwordx4 v[228:231], v1, s[8:11], s51 offen offset:1024 sc1
  s_branch ls_40
ls_39:
  buffer_store_dwordx4 v[224:227], v1, s[8:11], s51 offen
  buffer_store_dwordx4 v[228:231], v1, s[8:11], s51 offen offset:1024
ls_40:
  v_dot2_f32_bf16 v232, v224, s19, 0
  v_dot2_f32_bf16 v233, v224, v224, 0
  v_dot2_f32_bf16 v232, v225, s19, v232
  v_dot2_f32_bf16 v233, v225, v225, v233
  v_dot2_f32_bf16 v232, v226, s19, v232
  v_dot2_f32_bf16 v233, v226, v226, v233
  v_dot2_f32_bf16 v232, v227, s19, v232
  v_dot2_f32_bf16 v233, v227, v227, v233
  v_dot2_f32_bf16 v232, v228, s19, v232
  v_dot2_f32_bf16 v233, v228, v228, v233
  v_dot2_f32_bf16 v232, v229, s19, v232
  v_dot2_f32_bf16 v233, v229, v229, v233
  v_dot2_f32_bf16 v232, v230, s19, v232
  v_dot2_f32_bf16 v233, v230, v230, v233
  v_dot2_f32_bf16 v232, v231, s19, v232
  v_dot2_f32_bf16 v233, v231, v231, v233
  s_nop 2
  v_permlane32_swap_b32 v232, v233
  v_add_f32 v232, v232, v233
  s_cmp_lg_u32 s44, 0
  s_cbranch_scc1 ls_41
  buffer_store_dword v232, v239, s[8:11], s52 offen sc1
  s_branch ls_42
ls_41:
  buffer_store_dword v232, v239, s[8:11], s52 offen
ls_42:
  s_lshl_b32 s7, s40, 2
  s_add_u32 s7, s7, s4
  s_mul_i32 s20, s7, 28672
  s_add_u32 s20, s20, 0
  s_lshl_b32 s21, s7, 8
  s_add_u32 s21, s21, 1835008
  v_lshlrev_b32 v243, 3, v2
  v_lshl_add_u32 v243, v3, 14, v243
  s_lshl_b32 s18, s4, 7
  s_add_u32 s18, s18, 159744
  v_lshl_add_u32 v240, v2, 2, s18
  v_lshl_add_u32 v241, v3, 4, s18
  s_mov_b32 s17, 0x07060302
  s_add_u32 s87, s86, 2097152
  s_add_u32 s88, s84, 0
  s_add_u32 s89, s85, 1835008
  v_lshlrev_b32 v250, 1, v1
  v_lshrrev_b32 v5, 4, v1
  s_lshr_b32 s48, s7, 3
  s_lshr_b32 s49, s7, 1
  s_and_b32 s49, s49, 3
  s_lshl_b32 s49, s49, 3
  s_add_u32 s48, s48, s49
  v_lshl_add_u32 v4, v5, 5, s48
  v_lshlrev_b32 v4, 7, v4
  v_add_u32 v4, 15499264, v4
  v_cmp_eq_u32 s[56:57], 0, v3
  s_nop 1
  v_cndmask_b32 v16, 0, v9, s[56:57]
  v_and_b32 v17, 0xffff0000, v16
  v_sub_f32 v16, v16, v17
  v_and_b32 v18, 0xffff0000, v16
  v_sub_f32 v19, v16, v18
  v_perm_b32 v220, v18, v17, s17
  v_perm_b32 v221, v17, v19, s17
  v_perm_b32 v222, v17, v18, s17
  v_mov_b32 v223, 0
  v_cndmask_b32 v16, 0, v10, s[56:57]
  v_and_b32 v17, 0xffff0000, v16
  v_sub_f32 v16, v16, v17
  v_and_b32 v18, 0xffff0000, v16
  v_sub_f32 v19, v16, v18
  v_perm_b32 v224, v18, v17, s17
  v_perm_b32 v225, v17, v19, s17
  v_perm_b32 v226, v17, v18, s17
  v_mov_b32 v227, 0
  v_cndmask_b32 v16, 0, v8, s[56:57]
  v_and_b32 v17, 0xffff0000, v16
  v_sub_f32 v16, v16, v17
  v_and_b32 v18, 0xffff0000, v16
  v_sub_f32 v19, v16, v18
  v_perm_b32 v216, v18, v17, s17
  v_perm_b32 v217, v17, v19, s17
  v_perm_b32 v218, v17, v18, s17
  v_mov_b32 v219, 0
  ds_read_b128 v[176:179], v1 offset:1024
  ds_read_b128 v[180:183], v1 offset:2048
  ds_read_b128 v[184:187], v1 offset:4096
  ds_read_b128 v[188:191], v1 offset:5120
  ds_read_b128 v[192:195], v1 offset:7168
  s_waitcnt vmcnt(0) lgkmcnt(0)
  s_barrier
  s_cmp_lg_u32 s4, 0
  s_cbranch_scc1 sig_43
  s_add_u32 s48, s62, 1
  v_mov_b32 v244, s48
  v_mov_b32 v246, 0
  s_mov_b64 exec, 1
  s_add_u32 s48, s46, 32768
  s_cmp_lg_u32 s44, 0
  s_cbranch_scc1 ls_44
  buffer_store_dword v244, v246, s[8:11], s48 offen sc1
  s_branch ls_45
ls_44:
  buffer_store_dword v244, v246, s[8:11], s48 offen
ls_45:
  s_mov_b64 exec, -1
  s_nop 1
sig_43:
  s_branch op_join_36
op_skip_37:
  s_sub_u32 m0, s61, 21504
  s_sub_u32 s59, s60, 21504
  buffer_load_dwordx4 v1, s[8:11], s59 offen sc1 lds
  s_sub_u32 m0, s61, 18432
  s_sub_u32 s59, s60, 18432
  buffer_load_dwordx4 v1, s[8:11], s59 offen sc1 lds
  s_sub_u32 m0, s61, 15360
  s_sub_u32 s59, s60, 15360
  buffer_load_dwordx4 v1, s[8:11], s59 offen sc1 lds
  s_sub_u32 m0, s61, 12288
  s_sub_u32 s59, s60, 12288
  buffer_load_dwordx4 v1, s[8:11], s59 offen sc1 lds
  s_sub_u32 m0, s61, 9216
  s_sub_u32 s59, s60, 9216
  buffer_load_dwordx4 v1, s[8:11], s59 offen sc1 lds
  s_sub_u32 m0, s61, 6144
  s_sub_u32 s59, s60, 6144
  buffer_load_dwordx4 v1, s[8:11], s59 offen sc1 lds
  s_sub_u32 m0, s61, 3072
  s_sub_u32 s59, s60, 3072
  buffer_load_dwordx4 v1, s[8:11], s59 offen sc1 lds
  s_waitcnt vmcnt(0)
  s_barrier
  s_lshl_b32 s7, s40, 2
  s_add_u32 s7, s7, s4
  s_mul_i32 s20, s7, 28672
  s_add_u32 s20, s20, 0
  s_lshl_b32 s21, s7, 8
  s_add_u32 s21, s21, 1835008
  v_lshlrev_b32 v243, 3, v2
  v_lshl_add_u32 v243, v3, 14, v243
  s_lshl_b32 s18, s4, 7
  s_add_u32 s18, s18, 159744
  v_lshl_add_u32 v240, v2, 2, s18
  v_lshl_add_u32 v241, v3, 4, s18
  s_mov_b32 s17, 0x07060302
  s_add_u32 s87, s86, 2097152
  s_add_u32 s88, s84, 0
  s_add_u32 s89, s85, 1835008
  v_lshlrev_b32 v250, 1, v1
  v_lshrrev_b32 v5, 4, v1
  s_lshr_b32 s48, s7, 3
  s_lshr_b32 s49, s7, 1
  s_and_b32 s49, s49, 3
  s_lshl_b32 s49, s49, 3
  s_add_u32 s48, s48, s49
  v_lshl_add_u32 v4, v5, 5, s48
  v_lshlrev_b32 v4, 7, v4
  v_add_u32 v4, 15499264, v4
  v_cmp_eq_u32 s[56:57], 0, v3
  s_nop 1
  v_cndmask_b32 v16, 0, v9, s[56:57]
  v_and_b32 v17, 0xffff0000, v16
  v_sub_f32 v16, v16, v17
  v_and_b32 v18, 0xffff0000, v16
  v_sub_f32 v19, v16, v18
  v_perm_b32 v220, v18, v17, s17
  v_perm_b32 v221, v17, v19, s17
  v_perm_b32 v222, v17, v18, s17
  v_mov_b32 v223, 0
  v_cndmask_b32 v16, 0, v10, s[56:57]
  v_and_b32 v17, 0xffff0000, v16
  v_sub_f32 v16, v16, v17
  v_and_b32 v18, 0xffff0000, v16
  v_sub_f32 v19, v16, v18
  v_perm_b32 v224, v18, v17, s17
  v_perm_b32 v225, v17, v19, s17
  v_perm_b32 v226, v17, v18, s17
  v_mov_b32 v227, 0
  v_cndmask_b32 v16, 0, v8, s[56:57]
  v_and_b32 v17, 0xffff0000, v16
  v_sub_f32 v16, v16, v17
  v_and_b32 v18, 0xffff0000, v16
  v_sub_f32 v19, v16, v18
  v_perm_b32 v216, v18, v17, s17
  v_perm_b32 v217, v17, v19, s17
  v_perm_b32 v218, v17, v18, s17
  v_mov_b32 v219, 0
  ds_read_b128 v[176:179], v1 offset:1024
  ds_read_b128 v[180:183], v1 offset:2048
  ds_read_b128 v[184:187], v1 offset:4096
  ds_read_b128 v[188:191], v1 offset:5120
  ds_read_b128 v[192:195], v1 offset:7168
  s_waitcnt vmcnt(0) lgkmcnt(0)
  s_barrier
op_join_36:
  s_add_u32 s62, s62, 1
  s_cmp_lg_u32 s63, 0
  s_cbranch_scc1 k_fin
  s_mov_b64 exec, 127
  s_mov_b32 s48, 400000
  s_waitcnt lgkmcnt(0)
poll_46:
  buffer_load_dword v6, v4, s[8:11], 0 offen sc1
  s_sub_u32 s48, s48, 1
  s_cbranch_scc1 k_end
  s_waitcnt vmcnt(0)
  v_cmp_le_u32 vcc, s62, v6
  s_nop 0
  s_cmp_eq_u64 vcc, exec
  s_cbranch_scc0 poll_46
  s_mov_b64 exec, -1
  buffer_load_dwordx4 v[16:19], v1, s[8:11], s20 offen offset:0 sc1
  buffer_load_dwordx4 v[20:23], v1, s[8:11], s20 offen offset:1024 sc1
  buffer_load_dwordx4 v[24:27], v1, s[8:11], s20 offen offset:2048 sc1
  buffer_load_dwordx4 v[28:31], v1, s[8:11], s20 offen offset:3072 sc1
  s_add_u32 s20, s20, 4096
  buffer_load_dwordx4 v[32:35], v1, s[8:11], s20 offen offset:0 sc1
  buffer_load_dwordx4 v[36:39], v1, s[8:11], s20 offen offset:1024 sc1
  buffer_load_dwordx4 v[40:43], v1, s[8:11], s20 offen offset:2048 sc1
  buffer_load_dwordx4 v[44:47], v1, s[8:11], s20 offen offset:3072 sc1
  s_add_u32 s20, s20, 4096
  s_waitcnt vmcnt(7)
  v_mfma_f32_32x32x16_bf16 v[128:143], v[16:19], v[176:179], 0
  buffer_load_dwordx4 v[48:51], v1, s[8:11], s20 offen offset:0 sc1
  buffer_load_dwordx4 v[52:55], v1, s[8:11], s20 offen offset:1024 sc1
  ds_read_b128 v[196:199], v1 offset:8192
  v_mfma_f32_32x32x16_bf16 v[144:159], v[16:19], v[180:183], 0
  buffer_load_dwordx2 v[160:161], v243, s[8:11], s21 offen sc1
  s_add_u32 s21, s21, 32768
  buffer_load_dwordx2 v[162:163], v243, s[8:11], s21 offen sc1
  s_add_u32 s21, s21, 32768
  buffer_load_dwordx2 v[164:165], v243, s[8:11], s21 offen sc1
  s_add_u32 s21, s21, 32768
  buffer_load_dwordx2 v[166:167], v243, s[8:11], s21 offen sc1
  s_add_u32 s21, s21, 32768
  buffer_load_dwordx2 v[168:169], v243, s[8:11], s21 offen sc1
  s_add_u32 s21, s21, 32768
  buffer_load_dwordx2 v[170:171], v243, s[8:11], s21 offen sc1
  s_add_u32 s21, s21, 32768
  buffer_load_dwordx2 v[172:173], v243, s[8:11], s21 offen sc1
  ds_read_b128 v[176:179], v1 offset:10240
  s_waitcnt vmcnt(15)
  v_mfma_f32_32x32x16_bf16 v[128:143], v[20:23], v[184:187], v[128:143]
  buffer_load_dwordx4 v[56:59], v1, s[8:11], s20 offen offset:2048 sc1
  buffer_load_dwordx4 v[60:63], v1, s[8:11], s20 offen offset:3072 sc1
  s_add_u32 s20, s20, 4096
  ds_read_b128 v[180:183], v1 offset:11264
  v_mfma_f32_32x32x16_bf16 v[144:159], v[20:23], v[188:191], v[144:159]
  ds_read_b128 v[184:187], v1 offset:13312
  s_waitcnt vmcnt(16)
  v_mfma_f32_32x32x16_bf16 v[128:143], v[24:27], v[192:195], v[128:143]
  buffer_load_dwordx4 v[64:67], v1, s[8:11], s20 offen offset:0 sc1
  buffer_load_dwordx4 v[68:71], v1, s[8:11], s20 offen offset:1024 sc1
  ds_read_b128 v[188:191], v1 offset:14336
  s_waitcnt lgkmcnt(4)
  v_mfma_f32_32x32x16_bf16 v[144:159], v[24:27], v[196:199], v[144:159]
  ds_read_b128 v[192:195], v1 offset:16384
  s_waitcnt vmcnt(17) lgkmcnt(4)
  v_mfma_f32_32x32x16_bf16 v[128:143], v[28:31], v[176:179], v[128:143]
  buffer_load_dwordx4 v[72:75], v1, s[8:11], s20 offen offset:2048 sc1
  buffer_load_dwordx4 v[76:79], v1, s[8:11], s20 offen offset:3072 sc1
  s_add_u32 s20, s20, 4096
  ds_read_b128 v[196:199], v1 offset:17408
  s_waitcnt lgkmcnt(4)
  v_mfma_f32_32x32x16_bf16 v[144:159], v[28:31], v[180:183], v[144:159]
  ds_read_b128 v[176:179], v1 offset:19456
  s_waitcnt vmcnt(18) lgkmcnt(4)
  v_mfma_f32_32x32x16_bf16 v[128:143], v[32:35], v[184:187], v[128:143]
  buffer_load_dwordx4 v[80:83], v1, s[8:11], s20 offen offset:0 sc1
  buffer_load_dwordx4 v[84:87], v1, s[8:11], s20 offen offset:1024 sc1
  ds_read_b128 v[180:183], v1 offset:20480
  s_waitcnt lgkmcnt(4)
  v_mfma_f32_32x32x16_bf16 v[144:159], v[32:35], v[188:191], v[144:159]
  ds_read_b128 v[184:187], v1 offset:22528
  s_waitcnt vmcnt(19) lgkmcnt(4)
  v_mfma_f32_32x32x16_bf16 v[128:143], v[36:39], v[192:195], v[128:143]
  buffer_load_dwordx4 v[88:91], v1, s[8:11], s20 offen offset:2048 sc1
  buffer_load_dwordx4 v[92:95], v1, s[8:11], s20 offen offset:3072 sc1
  s_add_u32 s20, s20, 4096
  ds_read_b128 v[188:191], v1 offset:23552
  s_waitcnt lgkmcnt(4)
  v_mfma_f32_32x32x16_bf16 v[144:159], v[36:39], v[196:199], v[144:159]
  ds_read_b128 v[192:195], v1 offset:25600
  s_waitcnt vmcnt(20) lgkmcnt(4)
  v_mfma_f32_32x32x16_bf16 v[128:143], v[40:43], v[176:179], v[128:143]
  buffer_load_dwordx4 v[96:99], v1, s[8:11], s20 offen offset:0 sc1
  ds_read_b128 v[196:199], v1 offset:26624
  s_waitcnt lgkmcnt(4)
  v_mfma_f32_32x32x16_bf16 v[144:159], v[40:43], v[180:183], v[144:159]
  ds_read_b128 v[176:179], v1 offset:28672
  s_waitcnt vmcnt(20) lgkmcnt(4)
  v_mfma_f32_32x32x16_bf16 v[128:143], v[44:47], v[184:187], v[128:143]
  buffer_load_dwordx4 v[100:103], v1, s[8:11], s20 offen offset:1024 sc1
  ds_read_b128 v[180:183], v1 offset:29696
  s_waitcnt lgkmcnt(4)
  v_mfma_f32_32x32x16_bf16 v[144:159], v[44:47], v[188:191], v[144:159]
  ds_read_b128 v[184:187], v1 offset:31744
  s_waitcnt vmcnt(20) lgkmcnt(4)
  v_mfma_f32_32x32x16_bf16 v[128:143], v[48:51], v[192:195], v[128:143]
  buffer_load_dwordx4 v[104:107], v1, s[8:11], s20 offen offset:2048 sc1
  ds_read_b128 v[188:191], v1 offset:32768
  s_waitcnt lgkmcnt(4)
  v_mfma_f32_32x32x16_bf16 v[144:159], v[48:51], v[196:199], v[144:159]
  ds_read_b128 v[192:195], v1 offset:34816
  s_waitcnt vmcnt(20) lgkmcnt(4)
  v_mfma_f32_32x32x16_bf16 v[128:143], v[52:55], v[176:179], v[128:143]
  buffer_load_dwordx4 v[108:111], v1, s[8:11], s20 offen offset:3072 sc1
  s_add_u32 s20, s20, 4096
  ds_read_b128 v[196:199], v1 offset:35840
  s_waitcnt lgkmcnt(4)
  v_mfma_f32_32x32x16_bf16 v[144:159], v[52:55], v[180:183], v[144:159]
  ds_read_b128 v[176:179], v1 offset:37888
  s_waitcnt vmcnt(13) lgkmcnt(4)
  v_mfma_f32_32x32x16_bf16 v[128:143], v[56:59], v[184:187], v[128:143]
  buffer_load_dwordx4 v[112:115], v1, s[8:11], s20 offen offset:0 sc1
  ds_read_b128 v[180:183], v1 offset:38912
  s_waitcnt lgkmcnt(4)
  v_mfma_f32_32x32x16_bf16 v[144:159], v[56:59], v[188:191], v[144:159]
  ds_read_b128 v[184:187], v1 offset:40960
  s_waitcnt vmcnt(13) lgkmcnt(4)
  v_mfma_f32_32x32x16_bf16 v[128:143], v[60:63], v[192:195], v[128:143]
  buffer_load_dwordx4 v[116:119], v1, s[8:11], s20 offen offset:1024 sc1
  ds_read_b128 v[188:191], v1 offset:41984
  s_waitcnt lgkmcnt(4)
  v_mfma_f32_32x32x16_bf16 v[144:159], v[60:63], v[196:199], v[144:159]
  ds_read_b128 v[192:195], v1 offset:44032
  s_waitcnt vmcnt(13) lgkmcnt(4)
  v_mfma_f32_32x32x16_bf16 v[128:143], v[64:67], v[176:179], v[128:143]
  buffer_load_dwordx4 v[120:123], v1, s[8:11], s20 offen offset:2048 sc1
  ds_read_b128 v[196:199], v1 offset:45056
  v_add_f32 v160, v160, v162
  v_add_f32 v161, v161, v163
  s_waitcnt lgkmcnt(4)
  v_mfma_f32_32x32x16_bf16 v[144:159], v[64:67], v[180:183], v[144:159]
  ds_read_b128 v[176:179], v1 offset:47104
  v_add_f32 v160, v160, v164
  v_add_f32 v161, v161, v165
  s_waitcnt vmcnt(13) lgkmcnt(4)
  v_mfma_f32_32x32x16_bf16 v[128:143], v[68:71], v[184:187], v[128:143]
  buffer_load_dwordx4 v[124:127], v1, s[8:11], s20 offen offset:3072 sc1
  ds_read_b128 v[180:183], v1 offset:48128
  v_add_f32 v160, v160, v166
  v_add_f32 v161, v161, v167
  s_waitcnt lgkmcnt(4)
  v_mfma_f32_32x32x16_bf16 v[144:159], v[68:71], v[188:191], v[144:159]
  ds_read_b128 v[184:187], v1 offset:50176
  v_add_f32 v160, v160, v168
  v_add_f32 v161, v161, v169
  s_waitcnt vmcnt(13) lgkmcnt(4)
  v_mfma_f32_32x32x16_bf16 v[128:143], v[72:75], v[192:195], v[128:143]
  ds_read_b128 v[188:191], v1 offset:51200
  v_add_f32 v160, v160, v170
  v_add_f32 v161, v161, v171
  s_waitcnt lgkmcnt(4)
  v_mfma_f32_32x32x16_bf16 v[144:159], v[72:75], v[196:199], v[144:159]
  ds_read_b128 v[192:195], v1 offset:53248
  v_add_f32 v160, v160, v172
  v_add_f32 v161, v161, v173
  s_waitcnt vmcnt(12) lgkmcnt(4)
  v_mfma_f32_32x32x16_bf16 v[128:143], v[76:79], v[176:179], v[128:143]
  ds_read_b128 v[196:199], v1 offset:54272
  v_mov_b32 v162, v160
  v_mov_b32 v163, v161
  s_waitcnt lgkmcnt(4)
  v_mfma_f32_32x32x16_bf16 v[144:159], v[76:79], v[180:183], v[144:159]
  ds_read_b128 v[176:179], v1 offset:56320
  v_permlane32_swap_b32 v160, v162
  v_permlane32_swap_b32 v161, v163
  s_waitcnt vmcnt(11) lgkmcnt(4)
  v_mfma_f32_32x32x16_bf16 v[128:143], v[80:83], v[184:187], v[128:143]
  ds_read_b128 v[180:183], v1 offset:57344
  v_add_f32 v160, v160, v162
  v_add_f32 v161, v161, v163
  s_waitcnt lgkmcnt(4)
  v_mfma_f32_32x32x16_bf16 v[144:159], v[80:83], v[188:191], v[144:159]
  ds_read_b128 v[184:187], v1 offset:59392
  s_mov_b32 s16, 0x3b124925
  v_mul_f32 v160, s16, v160
  s_waitcnt vmcnt(10) lgkmcnt(4)
  v_mfma_f32_32x32x16_bf16 v[128:143], v[84:87], v[192:195], v[128:143]
  ds_read_b128 v[188:191], v1 offset:60416
  v_mul_f32 v161, s16, v161
  v_fma_f32 v161, -v160, v160, v161
  s_waitcnt lgkmcnt(4)
  v_mfma_f32_32x32x16_bf16 v[144:159], v[84:87], v[196:199], v[144:159]
  buffer_load_dword v255, v250, s[8:11], s87 offen sc1
  buffer_load_dword v255, v250, s[8:11], s88 offen sc1
  s_mov_b64 exec, 0xff
  buffer_load_dword v255, v250, s[8:11], s89 offen sc1
  s_mov_b64 exec, -1
  ds_read_b128 v[192:195], v1 offset:62464
  v_max_f32 v161, 0, v161
  v_add_f32 v161, 0x3727c5ac, v161
  s_waitcnt vmcnt(12) lgkmcnt(4)
  v_mfma_f32_32x32x16_bf16 v[128:143], v[88:91], v[176:179], v[128:143]
  ds_read_b128 v[196:199], v1 offset:63488
  v_rsq_f32 v232, v161
  v_sub_f32 v160, 0, v160
  s_waitcnt lgkmcnt(4)
  v_mfma_f32_32x32x16_bf16 v[144:159], v[88:91], v[180:183], v[144:159]
  ds_read_b128 v[176:179], v14 offset:0
  ds_write_b32 v240, v232
  ds_read_b128 v[200:203], v241 offset:0
  s_waitcnt vmcnt(11) lgkmcnt(6)
  v_mfma_f32_32x32x16_bf16 v[128:143], v[92:95], v[184:187], v[128:143]
  ds_read_b128 v[180:183], v14 offset:1024
  ds_read_b128 v[204:207], v241 offset:32
  ds_read_b128 v[208:211], v241 offset:64
  s_waitcnt lgkmcnt(8)
  v_mfma_f32_32x32x16_bf16 v[144:159], v[92:95], v[188:191], v[144:159]
  ds_read_b128 v[184:187], v14 offset:3072
  ds_read_b128 v[212:215], v241 offset:96
  v_and_b32 v236, 0xffff0000, v160
  s_waitcnt vmcnt(10) lgkmcnt(9)
  v_mfma_f32_32x32x16_bf16 v[128:143], v[96:99], v[192:195], v[128:143]
  ds_read_b128 v[188:191], v14 offset:4096
  v_sub_f32 v237, v160, v236
  v_and_b32 v238, 0xffff0000, v237
  s_waitcnt lgkmcnt(9)
  v_mfma_f32_32x32x16_bf16 v[144:159], v[96:99], v[196:199], v[144:159]
  ds_read_b128 v[192:195], v14 offset:6144
  v_sub_f32 v239, v237, v238
  v_perm_b32 v228, v236, v236, s17
  s_waitcnt vmcnt(9) lgkmcnt(9)
  v_mfma_f32_32x32x16_bf16 v[128:143], v[100:103], v[176:179], v[128:143]
  ds_read_b128 v[196:199], v14 offset:7168
  v_perm_b32 v229, v238, v236, s17
  v_perm_b32 v230, v239, v238, s17
  s_waitcnt lgkmcnt(7)
  v_mfma_f32_32x32x16_bf16 v[144:159], v[100:103], v[180:183], v[144:159]
  ds_read_b128 v[176:179], v14 offset:9216
  v_mov_b32 v231, 0
  v_mul_f32 v234, 0x3fb8aa3b, v232
  s_waitcnt vmcnt(8) lgkmcnt(5)
  v_mfma_f32_32x32x16_bf16 v[128:143], v[104:107], v[184:187], v[128:143]
  ds_read_b128 v[180:183], v14 offset:10240
  s_waitcnt lgkmcnt(4)
  v_mfma_f32_32x32x16_bf16 v[144:159], v[104:107], v[188:191], v[144:159]
  ds_read_b128 v[184:187], v14 offset:12288
  s_waitcnt vmcnt(7) lgkmcnt(4)
  v_mfma_f32_32x32x16_bf16 v[128:143], v[108:111], v[192:195], v[128:143]
  ds_read_b128 v[188:191], v14 offset:13312
  s_waitcnt lgkmcnt(4)
  v_mfma_f32_32x32x16_bf16 v[144:159], v[108:111], v[196:199], v[144:159]
  ds_read_b128 v[192:195], v14 offset:15360
  v_mfma_f32_32x32x16_bf16 v[128:143], v[228:231], v[220:223], v[128:143]
  v_mfma_f32_32x32x16_bf16 v[144:159], v[228:231], v[224:227], v[144:159]
  s_waitcnt vmcnt(6) lgkmcnt(4)
  v_mfma_f32_32x32x16_bf16 v[128:143], v[112:115], v[176:179], v[128:143]
  ds_read_b128 v[196:199], v14 offset:16384
  s_waitcnt lgkmcnt(4)
  v_mfma_f32_32x32x16_bf16 v[144:159], v[112:115], v[180:183], v[144:159]
  ds_read_b128 v[176:179], v14 offset:18432
  s_waitcnt vmcnt(5) lgkmcnt(4)
  v_mfma_f32_32x32x16_bf16 v[128:143], v[116:119], v[184:187], v[128:143]
  ds_read_b128 v[180:183], v14 offset:19456
  s_waitcnt lgkmcnt(4)
  v_mfma_f32_32x32x16_bf16 v[144:159], v[116:119], v[188:191], v[144:159]
  ds_read_b128 v[184:187], v1 offset:0
  s_waitcnt vmcnt(4) lgkmcnt(4)
  v_mfma_f32_32x32x16_bf16 v[128:143], v[120:123], v[192:195], v[128:143]
  ds_read_b128 v[188:191], v1 offset:3072
  s_waitcnt lgkmcnt(4)
  v_mfma_f32_32x32x16_bf16 v[144:159], v[120:123], v[196:199], v[144:159]
  ds_read_b128 v[192:195], v1 offset:6144
  s_waitcnt vmcnt(3) lgkmcnt(4)
  v_mfma_f32_32x32x16_bf16 v[128:143], v[124:127], v[176:179], v[128:143]
  ds_read_b128 v[196:199], v1 offset:9216
  s_waitcnt lgkmcnt(4)
  v_mfma_f32_32x32x16_bf16 v[144:159], v[124:127], v[180:183], v[144:159]
  ds_read_b128 v[176:179], v1 offset:12288
  s_mov_b32 s16, 0x358637bd
  s_mov_b32 s17, 0x358637bd
  s_mov_b32 s18, 0x3fb8aa3b
  s_lshl_b32 s19, s4, 12
  s_add_u32 s19, s19, 143360
  v_add_u32 v240, s19, v1
  v_lshlrev_b32 v239, 2, v0
  v_add_u32 v241, 143360, v239
  v_mov_b32 v236, 1.0
  v_pk_mul_f32 v[128:129], v[128:129], v[200:201]
  v_pk_mul_f32 v[244:245], v[128:129], s[18:19] op_sel_hi:[1,0]
  v_pk_add_f32 v[128:129], v[128:129], 1.0 op_sel_hi:[1,0]
  v_exp_f32 v244, v244
  v_exp_f32 v245, v245
  v_med3_f32 v128, v244, v128, 1.0
  v_med3_f32 v129, v245, v129, 1.0
  v_pk_add_f32 v[128:129], v[128:129], s[16:17]
  v_cvt_pk_bf16_f32 v128, v128, v129
  v_pk_mul_f32 v[130:131], v[130:131], v[202:203]
  v_pk_mul_f32 v[246:247], v[130:131], s[18:19] op_sel_hi:[1,0]
  v_pk_add_f32 v[130:131], v[130:131], 1.0 op_sel_hi:[1,0]
  v_exp_f32 v246, v246
  v_exp_f32 v247, v247
  v_med3_f32 v130, v246, v130, 1.0
  v_med3_f32 v131, v247, v131, 1.0
  v_pk_add_f32 v[130:131], v[130:131], s[16:17]
  v_cvt_pk_bf16_f32 v129, v130, v131
  v_pk_mul_f32 v[132:133], v[132:133], v[204:205]
  v_pk_mul_f32 v[248:249], v[132:133], s[18:19] op_sel_hi:[1,0]
  v_pk_add_f32 v[132:133], v[132:133], 1.0 op_sel_hi:[1,0]
  v_exp_f32 v248, v248
  v_exp_f32 v249, v249
  v_med3_f32 v132, v248, v132, 1.0
  v_med3_f32 v133, v249, v133, 1.0
  v_pk_add_f32 v[132:133], v[132:133], s[16:17]
  v_cvt_pk_bf16_f32 v130, v132, v133
  v_pk_mul_f32 v[134:135], v[134:135], v[206:207]
  v_pk_mul_f32 v[244:245], v[134:135], s[18:19] op_sel_hi:[1,0]
  v_pk_add_f32 v[134:135], v[134:135], 1.0 op_sel_hi:[1,0]
  v_exp_f32 v244, v244
  v_exp_f32 v245, v245
  v_med3_f32 v134, v244, v134, 1.0
  v_med3_f32 v135, v245, v135, 1.0
  v_pk_add_f32 v[134:135], v[134:135], s[16:17]
  v_cvt_pk_bf16_f32 v131, v134, v135
  v_pk_mul_f32 v[136:137], v[136:137], v[208:209]
  v_pk_mul_f32 v[246:247], v[136:137], s[18:19] op_sel_hi:[1,0]
  v_pk_add_f32 v[136:137], v[136:137], 1.0 op_sel_hi:[1,0]
  v_exp_f32 v246, v246
  v_exp_f32 v247, v247
  v_med3_f32 v136, v246, v136, 1.0
  v_med3_f32 v137, v247, v137, 1.0
  v_pk_add_f32 v[136:137], v[136:137], s[16:17]
  v_cvt_pk_bf16_f32 v132, v136, v137
  v_pk_mul_f32 v[138:139], v[138:139], v[210:211]
  v_pk_mul_f32 v[248:249], v[138:139], s[18:19] op_sel_hi:[1,0]
  v_pk_add_f32 v[138:139], v[138:139], 1.0 op_sel_hi:[1,0]
  v_exp_f32 v248, v248
  v_exp_f32 v249, v249
  v_med3_f32 v138, v248, v138, 1.0
  v_med3_f32 v139, v249, v139, 1.0
  v_pk_add_f32 v[138:139], v[138:139], s[16:17]
  v_cvt_pk_bf16_f32 v133, v138, v139
  v_pk_mul_f32 v[140:141], v[140:141], v[212:213]
  v_pk_mul_f32 v[244:245], v[140:141], s[18:19] op_sel_hi:[1,0]
  v_pk_add_f32 v[140:141], v[140:141], 1.0 op_sel_hi:[1,0]
  v_exp_f32 v244, v244
  v_exp_f32 v245, v245
  v_med3_f32 v140, v244, v140, 1.0
  v_med3_f32 v141, v245, v141, 1.0
  v_pk_add_f32 v[140:141], v[140:141], s[16:17]
  v_cvt_pk_bf16_f32 v134, v140, v141
  v_pk_mul_f32 v[142:143], v[142:143], v[214:215]
  v_pk_mul_f32 v[246:247], v[142:143], s[18:19] op_sel_hi:[1,0]
  v_pk_add_f32 v[142:143], v[142:143], 1.0 op_sel_hi:[1,0]
  v_exp_f32 v246, v246
  v_exp_f32 v247, v247
  v_med3_f32 v142, v246, v142, 1.0
  v_med3_f32 v143, v247, v143, 1.0
  v_pk_add_f32 v[142:143], v[142:143], s[16:17]
  v_cvt_pk_bf16_f32 v135, v142, v143
  v_pk_mul_f32 v[144:145], v[144:145], v[200:201]
  v_cvt_pk_bf16_f32 v136, v144, v145
  v_pk_mul_f32 v[146:147], v[146:147], v[202:203]
  v_cvt_pk_bf16_f32 v137, v146, v147
  v_pk_mul_f32 v[148:149], v[148:149], v[204:205]
  v_cvt_pk_bf16_f32 v138, v148, v149
  v_pk_mul_f32 v[150:151], v[150:151], v[206:207]
  v_cvt_pk_bf16_f32 v139, v150, v151
  v_pk_mul_f32 v[152:153], v[152:153], v[208:209]
  v_cvt_pk_bf16_f32 v140, v152, v153
  v_pk_mul_f32 v[154:155], v[154:155], v[210:211]
  v_cvt_pk_bf16_f32 v141, v154, v155
  v_pk_mul_f32 v[156:157], v[156:157], v[212:213]
  v_cvt_pk_bf16_f32 v142, v156, v157
  v_pk_mul_f32 v[158:159], v[158:159], v[214:215]
  v_cvt_pk_bf16_f32 v143, v158, v159
  s_mov_b32 exec_lo, 0xf0000000
  s_mov_b32 exec_hi, 0xf0000000
  v_mov_b32 v136, v15
  v_mov_b32 v137, v15
  v_mov_b32 v138, v15
  v_mov_b32 v139, v15
  v_mov_b32 v140, v15
  v_mov_b32 v141, v15
  v_mov_b32 v142, v15
  v_mov_b32 v143, v15
  s_mov_b64 exec, -1
  v_mfma_f32_32x32x16_bf16 v[144:159], v[128:131], v[136:139], 0
  v_mfma_f32_32x32x16_bf16 v[144:159], v[132:135], v[140:143], v[144:159]
  s_lshl_b32 s22, s41, 12
  s_add_u32 s22, s22, 15400960
  s_cmp_ge_u32 s4, 2
  s_cselect_b32 s23, 1073741824, s22
  s_lshl_b32 s12, s7, 15
  s_lshl_b32 s13, s41, 11
  s_add_u32 s12, s12, s13
  s_add_u32 s12, s12, 2097152
  s_mul_i32 s61, s4, 21504
  s_mul_i32 s60, s41, 86016
  s_add_u32 s60, s60, s61
  s_add_u32 s60, s60, 13959168
  v_mfma_f32_32x32x16_bf16 v[160:175], v[216:219], v[228:231], 0
  s_waitcnt lgkmcnt(4)
  v_mfma_f32_32x32x16_bf16 v[160:175], v[184:187], v[16:19], v[160:175]
  ds_read_b128 v[180:183], v1 offset:15360
  ds_write_b128 v240, v[144:147] offset:0
  s_waitcnt lgkmcnt(5)
  v_mfma_f32_32x32x16_bf16 v[160:175], v[188:191], v[20:23], v[160:175]
  ds_read_b128 v[184:187], v1 offset:18432
  ds_write_b128 v240, v[148:151] offset:1024
  s_waitcnt lgkmcnt(6)
  v_mfma_f32_32x32x16_bf16 v[160:175], v[192:195], v[24:27], v[160:175]
  ds_read_b128 v[188:191], v1 offset:21504
  ds_write_b128 v240, v[152:155] offset:2048
  s_waitcnt lgkmcnt(7)
  v_mfma_f32_32x32x16_bf16 v[160:175], v[196:199], v[28:31], v[160:175]
  ds_read_b128 v[192:195], v1 offset:24576
  ds_write_b128 v240, v[156:159] offset:3072
  s_waitcnt lgkmcnt(8)
  v_mfma_f32_32x32x16_bf16 v[160:175], v[176:179], v[32:35], v[160:175]
  ds_read_b128 v[196:199], v1 offset:27648
  s_waitcnt lgkmcnt(8)
  v_mfma_f32_32x32x16_bf16 v[160:175], v[180:183], v[36:39], v[160:175]
  ds_read_b128 v[176:179], v1 offset:30720
  s_waitcnt lgkmcnt(2)
  s_barrier
  ds_read2st64_b32 v[200:201], v241 offset0:0 offset1:16
  ds_read2st64_b32 v[202:203], v241 offset0:32 offset1:48
  ds_read2st64_b32 v[204:205], v241 offset0:4 offset1:20
  ds_read2st64_b32 v[206:207], v241 offset0:36 offset1:52
  ds_read2st64_b32 v[208:209], v241 offset0:8 offset1:24
  ds_read2st64_b32 v[210:211], v241 offset0:40 offset1:56
  ds_read2st64_b32 v[212:213], v241 offset0:12 offset1:28
  ds_read2st64_b32 v[214:215], v241 offset0:44 offset1:60
  v_mfma_f32_32x32x16_bf16 v[160:175], v[184:187], v[40:43], v[160:175]
  ds_read_b128 v[180:183], v1 offset:33792
  v_mfma_f32_32x32x16_bf16 v[160:175], v[188:191], v[44:47], v[160:175]
  ds_read_b128 v[184:187], v1 offset:36864
  v_mfma_f32_32x32x16_bf16 v[160:175], v[192:195], v[48:51], v[160:175]
  ds_read_b128 v[188:191], v1 offset:39936
  s_waitcnt lgkmcnt(10)
  v_add_f32 v200, v200, v201
  s_waitcnt lgkmcnt(9)
  v_add_f32 v202, v202, v203
  v_add_f32 v200, v200, v202
  buffer_atomic_add_f32 v200, v239, s[8:11], s22 offen offset:0 sc1
  s_waitcnt lgkmcnt(8)
  v_add_f32 v204, v204, v205
  s_waitcnt lgkmcnt(7)
  v_add_f32 v206, v206, v207
  v_add_f32 v204, v204, v206
  buffer_atomic_add_f32 v204, v239, s[8:11], s22 offen offset:1024 sc1
  v_mfma_f32_32x32x16_bf16 v[160:175], v[196:199], v[52:55], v[160:175]
  ds_read_b128 v[192:195], v1 offset:43008
  s_waitcnt lgkmcnt(7)
  v_add_f32 v208, v208, v209
  s_waitcnt lgkmcnt(6)
  v_add_f32 v210, v210, v211
  v_add_f32 v208, v208, v210
  buffer_atomic_add_f32 v208, v239, s[8:11], s22 offen offset:2048 sc1
  s_waitcnt lgkmcnt(5)
  v_add_f32 v212, v212, v213
  s_waitcnt lgkmcnt(4)
  v_add_f32 v214, v214, v215
  v_add_f32 v212, v212, v214
  buffer_atomic_add_f32 v212, v239, s[8:11], s23 offen offset:3072 sc1
  v_mfma_f32_32x32x16_bf16 v[160:175], v[176:179], v[56:59], v[160:175]
  ds_read_b128 v[196:199], v1 offset:46080
  s_waitcnt lgkmcnt(4)
  v_mfma_f32_32x32x16_bf16 v[160:175], v[180:183], v[60:63], v[160:175]
  ds_read_b128 v[176:179], v1 offset:49152
  s_waitcnt lgkmcnt(4)
  v_mfma_f32_32x32x16_bf16 v[160:175], v[184:187], v[64:67], v[160:175]
  ds_read_b128 v[180:183], v1 offset:52224
  s_waitcnt lgkmcnt(4)
  v_mfma_f32_32x32x16_bf16 v[160:175], v[188:191], v[68:71], v[160:175]
  ds_read_b128 v[184:187], v1 offset:55296
  s_waitcnt lgkmcnt(4)
  v_mfma_f32_32x32x16_bf16 v[160:175], v[192:195], v[72:75], v[160:175]
  ds_read_b128 v[188:191], v1 offset:58368
  s_waitcnt lgkmcnt(4)
  v_mfma_f32_32x32x16_bf16 v[160:175], v[196:199], v[76:79], v[160:175]
  ds_read_b128 v[192:195], v1 offset:61440
  s_waitcnt lgkmcnt(4)
  v_mfma_f32_32x32x16_bf16 v[160:175], v[176:179], v[80:83], v[160:175]
  ds_read_b128 v[196:199], v1 offset:64512
  s_waitcnt lgkmcnt(4)
  v_mfma_f32_32x32x16_bf16 v[160:175], v[180:183], v[84:87], v[160:175]
  ds_read_b128 v[176:179], v14 offset:2048
  s_waitcnt lgkmcnt(4)
  v_mfma_f32_32x32x16_bf16 v[160:175], v[184:187], v[88:91], v[160:175]
  ds_read_b128 v[180:183], v14 offset:5120
  s_waitcnt lgkmcnt(4)
  v_mfma_f32_32x32x16_bf16 v[160:175], v[188:191], v[92:95], v[160:175]
  ds_read_b128 v[184:187], v14 offset:8192
  s_waitcnt lgkmcnt(4)
  v_mfma_f32_32x32x16_bf16 v[160:175], v[192:195], v[96:99], v[160:175]
  ds_read_b128 v[188:191], v14 offset:11264
  s_waitcnt lgkmcnt(4)
  v_mfma_f32_32x32x16_bf16 v[160:175], v[196:199], v[100:103], v[160:175]
  ds_read_b128 v[192:195], v14 offset:14336
  s_waitcnt lgkmcnt(4)
  v_mfma_f32_32x32x16_bf16 v[160:175], v[176:179], v[104:107], v[160:175]
  ds_read_b128 v[196:199], v14 offset:17408
  s_waitcnt lgkmcnt(4)
  v_mfma_f32_32x32x16_bf16 v[160:175], v[180:183], v[108:111], v[160:175]
  s_waitcnt lgkmcnt(3)
  v_mfma_f32_32x32x16_bf16 v[160:175], v[184:187], v[112:115], v[160:175]
  s_waitcnt lgkmcnt(2)
  v_mfma_f32_32x32x16_bf16 v[160:175], v[188:191], v[116:119], v[160:175]
  s_waitcnt lgkmcnt(1)
  v_mfma_f32_32x32x16_bf16 v[160:175], v[192:195], v[120:123], v[160:175]
  s_waitcnt lgkmcnt(0)
  v_mfma_f32_32x32x16_bf16 v[160:175], v[196:199], v[124:127], v[160:175]
  s_waitcnt vmcnt(0)
  s_barrier
  s_cmp_lg_u32 s4, 0
  s_cbranch_scc1 sig_47
  s_add_u32 s48, s62, 1
  v_mov_b32 v244, s48
  v_mov_b32 v246, 0
  s_mov_b64 exec, 1
  buffer_store_dword v244, v246, s[8:11], s46 offen sc1
  s_mov_b64 exec, -1
  s_nop 1
sig_47:
  s_add_u32 s62, s62, 1
  s_add_u32 m0, s61, 0
  s_add_u32 s59, s60, 0
  buffer_load_dwordx4 v1, s[8:11], s59 offen offset:1024 sc1 lds
  buffer_load_dwordx4 v1, s[8:11], s59 offen offset:2048 sc1 lds
  s_add_u32 m0, s61, 3072
  s_add_u32 s59, s60, 3072
  buffer_load_dwordx4 v1, s[8:11], s59 offen offset:1024 sc1 lds
  buffer_load_dwordx4 v1, s[8:11], s59 offen offset:2048 sc1 lds
  s_add_u32 m0, s61, 6144
  s_add_u32 s59, s60, 6144
  buffer_load_dwordx4 v1, s[8:11], s59 offen offset:1024 sc1 lds
  buffer_load_dwordx4 v1, s[8:11], s59 offen offset:2048 sc1 lds
  s_add_u32 m0, s61, 9216
  s_add_u32 s59, s60, 9216
  buffer_load_dwordx4 v1, s[8:11], s59 offen offset:1024 sc1 lds
  buffer_load_dwordx4 v1, s[8:11], s59 offen offset:2048 sc1 lds
  s_add_u32 m0, s61, 12288
  s_add_u32 s59, s60, 12288
  buffer_load_dwordx4 v1, s[8:11], s59 offen offset:1024 sc1 lds
  buffer_load_dwordx4 v1, s[8:11], s59 offen offset:2048 sc1 lds
  v_pk_mul_f32 v[244:245], v[160:161], v[234:235] op_sel_hi:[1,0]
  v_pk_fma_f32 v[160:161], v[160:161], v[232:233], v[236:237] op_sel_hi:[1,0,0]
  v_exp_f32 v244, v244
  v_exp_f32 v245, v245
  v_med3_f32 v160, v244, v160, 1.0
  v_med3_f32 v161, v245, v161, 1.0
  v_pk_add_f32 v[160:161], v[160:161], s[16:17]
  v_cvt_pk_bf16_f32 v16, v160, v161
  v_pk_mul_f32 v[246:247], v[162:163], v[234:235] op_sel_hi:[1,0]
  v_pk_fma_f32 v[162:163], v[162:163], v[232:233], v[236:237] op_sel_hi:[1,0,0]
  v_exp_f32 v246, v246
  v_exp_f32 v247, v247
  v_med3_f32 v162, v246, v162, 1.0
  v_med3_f32 v163, v247, v163, 1.0
  v_pk_add_f32 v[162:163], v[162:163], s[16:17]
  v_cvt_pk_bf16_f32 v17, v162, v163
  v_pk_mul_f32 v[248:249], v[164:165], v[234:235] op_sel_hi:[1,0]
  v_pk_fma_f32 v[164:165], v[164:165], v[232:233], v[236:237] op_sel_hi:[1,0,0]
  v_exp_f32 v248, v248
  v_exp_f32 v249, v249
  v_med3_f32 v164, v248, v164, 1.0
  v_med3_f32 v165, v249, v165, 1.0
  v_pk_add_f32 v[164:165], v[164:165], s[16:17]
  v_cvt_pk_bf16_f32 v18, v164, v165
  v_pk_mul_f32 v[244:245], v[166:167], v[234:235] op_sel_hi:[1,0]
  v_pk_fma_f32 v[166:167], v[166:167], v[232:233], v[236:237] op_sel_hi:[1,0,0]
  v_exp_f32 v244, v244
  v_exp_f32 v245, v245
  v_med3_f32 v166, v244, v166, 1.0
  v_med3_f32 v167, v245, v167, 1.0
  v_pk_add_f32 v[166:167], v[166:167], s[16:17]
  v_cvt_pk_bf16_f32 v19, v166, v167
  v_pk_mul_f32 v[246:247], v[168:169], v[234:235] op_sel_hi:[1,0]
  v_pk_fma_f32 v[168:169], v[168:169], v[232:233], v[236:237] op_sel_hi:[1,0,0]
  v_exp_f32 v246, v246
  v_exp_f32 v247, v247
  v_med3_f32 v168, v246, v168, 1.0
  v_med3_f32 v169, v247, v169, 1.0
  v_pk_add_f32 v[168:169], v[168:169], s[16:17]
  v_cvt_pk_bf16_f32 v20, v168, v169
  v_pk_mul_f32 v[248:249], v[170:171], v[234:235] op_sel_hi:[1,0]
  v_pk_fma_f32 v[170:171], v[170:171], v[232:233], v[236:237] op_sel_hi:[1,0,0]
  v_exp_f32 v248, v248
  v_exp_f32 v249, v249
  v_med3_f32 v170, v248, v170, 1.0
  v_med3_f32 v171, v249, v171, 1.0
  v_pk_add_f32 v[170:171], v[170:171], s[16:17]
  v_cvt_pk_bf16_f32 v21, v170, v171
  v_pk_mul_f32 v[244:245], v[172:173], v[234:235] op_sel_hi:[1,0]
  v_pk_fma_f32 v[172:173], v[172:173], v[232:233], v[236:237] op_sel_hi:[1,0,0]
  v_exp_f32 v244, v244
  v_exp_f32 v245, v245
  v_med3_f32 v172, v244, v172, 1.0
  v_med3_f32 v173, v245, v173, 1.0
  v_pk_add_f32 v[172:173], v[172:173], s[16:17]
  v_cvt_pk_bf16_f32 v22, v172, v173
  v_pk_mul_f32 v[246:247], v[174:175], v[234:235] op_sel_hi:[1,0]
  v_pk_fma_f32 v[174:175], v[174:175], v[232:233], v[236:237] op_sel_hi:[1,0,0]
  v_exp_f32 v246, v246
  v_exp_f32 v247, v247
  v_med3_f32 v174, v246, v174, 1.0
  v_med3_f32 v175, v247, v175, 1.0
  v_pk_add_f32 v[174:175], v[174:175], s[16:17]
  v_cvt_pk_bf16_f32 v23, v174, v175
  s_mov_b32 exec_lo, 0
  v_mov_b32 v22, 0
  v_mov_b32 v23, 0
  s_mov_b32 exec_lo, -1
  s_add_u32 s48, s84, 0
  buffer_load_dwordx4 v[224:227], v1, s[8:11], s48 offen sc1
  buffer_load_dwordx4 v[228:231], v1, s[8:11], s48 offen offset:1024 sc1
  v_lshrrev_b32 v5, 4, v1
  v_lshrrev_b32 v4, 1, v5
  v_and_b32 v5, 1, v5
  v_lshl_add_u32 v4, v5, 3, v4
  s_lshl_b32 s48, s41, 4
  v_add_u32 v4, s48, v4
  v_lshlrev_b32 v4, 7, v4
  v_add_u32 v4, 15466496, v4
  s_mov_b64 exec, 65535
  s_mov_b32 s48, 400000
  s_waitcnt lgkmcnt(0)
poll_48:
  buffer_load_dword v6, v4, s[8:11], 0 offen sc1
  s_sub_u32 s48, s48, 1
  s_cbranch_scc1 k_end
  s_waitcnt vmcnt(0)
  v_cmp_le_u32 vcc, s62, v6
  s_nop 0
  s_cmp_eq_u64 vcc, exec
  s_cbranch_scc0 poll_48
  s_mov_b64 exec, -1
  buffer_load_dwordx4 v[40:43], v1, s[8:11], s22 offen offset:0 sc1
  buffer_load_dwordx4 v[44:47], v1, s[8:11], s22 offen offset:1024 sc1
  buffer_load_dwordx4 v[48:51], v1, s[8:11], s22 offen offset:2048 sc1
  buffer_load_dwordx4 v[52:55], v1, s[8:11], s22 offen offset:3072 sc1
  v_lshlrev_b32 v112, 16, v224
  v_and_b32 v113, 0xffff0000, v224
  v_lshlrev_b32 v114, 16, v225
  v_and_b32 v115, 0xffff0000, v225
  v_lshlrev_b32 v116, 16, v226
  v_and_b32 v117, 0xffff0000, v226
  v_lshlrev_b32 v118, 16, v227
  v_and_b32 v119, 0xffff0000, v227
  v_lshlrev_b32 v120, 16, v228
  v_and_b32 v121, 0xffff0000, v228
  v_lshlrev_b32 v122, 16, v229
  v_and_b32 v123, 0xffff0000, v229
  v_lshlrev_b32 v124, 16, v230
  v_and_b32 v125, 0xffff0000, v230
  v_lshlrev_b32 v126, 16, v231
  v_and_b32 v127, 0xffff0000, v231
  s_lshl_b32 s48, s4, 14
  s_and_b32 s48, s48, 0x8000
  s_add_u32 s48, s48, 86016
  v_add_u32 v236, s48, v1
  v_lshlrev_b32 v239, 3, v2
  v_lshl_add_u32 v239, v3, 2, v239
  s_lshr_b32 s50, s42, 1
  s_lshr_b32 s48, s50, 1
  s_and_b32 s49, s50, 1
  s_lshl_b32 s49, s49, 3
  s_add_u32 s48, s48, s49
  v_add_u32 v4, s48, v1
  v_lshlrev_b32 v4, 7, v4
  v_add_u32 v4, 15499264, v4
  s_waitcnt vmcnt(3)
  v_cvt_pk_bf16_f32 v40, v40, v41
  v_cvt_pk_bf16_f32 v41, v42, v43
  s_waitcnt vmcnt(2)
  v_cvt_pk_bf16_f32 v42, v44, v45
  v_cvt_pk_bf16_f32 v43, v46, v47
  s_nop 1
  v_mfma_f32_32x32x16_bf16 v[56:71], v[40:43], v[16:19], 0
  s_waitcnt vmcnt(1)
  v_cvt_pk_bf16_f32 v44, v48, v49
  v_cvt_pk_bf16_f32 v45, v50, v51
  s_waitcnt vmcnt(0)
  v_cvt_pk_bf16_f32 v46, v52, v53
  v_cvt_pk_bf16_f32 v47, v54, v55
  s_nop 1
  v_mfma_f32_32x32x16_bf16 v[56:71], v[44:47], v[20:23], v[56:71]
  s_nop 11
  v_add_f32 v232, s16, v68
  v_mov_b32 v233, v232
  s_nop 1
  v_permlane32_swap_b32 v233, v232
  v_rcp_f32 v232, v232
  s_nop 0
  v_pk_mul_f32 v[56:57], v[56:57], v[232:233] op_sel_hi:[1,0]
  v_cvt_pk_bf16_f32 v24, v56, v57
  v_pk_mul_f32 v[58:59], v[58:59], v[232:233] op_sel_hi:[1,0]
  v_cvt_pk_bf16_f32 v25, v58, v59
  v_pk_mul_f32 v[60:61], v[60:61], v[232:233] op_sel_hi:[1,0]
  v_cvt_pk_bf16_f32 v26, v60, v61
  v_pk_mul_f32 v[62:63], v[62:63], v[232:233] op_sel_hi:[1,0]
  v_cvt_pk_bf16_f32 v27, v62, v63
  v_pk_mul_f32 v[64:65], v[64:65], v[232:233] op_sel_hi:[1,0]
  v_cvt_pk_bf16_f32 v28, v64, v65
  v_pk_mul_f32 v[66:67], v[66:67], v[232:233] op_sel_hi:[1,0]
  v_cvt_pk_bf16_f32 v29, v66, v67
  v_pk_mul_f32 v[68:69], v[68:69], v[232:233] op_sel_hi:[1,0]
  v_cvt_pk_bf16_f32 v30, v68, v69
  v_pk_mul_f32 v[70:71], v[70:71], v[232:233] op_sel_hi:[1,0]
  v_cvt_pk_bf16_f32 v31, v70, v71
  s_cmp_lg_u32 s44, 0
  s_cbranch_scc1 ls_49
  buffer_store_dwordx4 v[24:27], v1, s[8:11], s12 offen sc1
  buffer_store_dwordx4 v[28:31], v1, s[8:11], s12 offen offset:1024 sc1
  s_branch ls_50
ls_49:
  buffer_store_dwordx4 v[24:27], v1, s[8:11], s12 offen
  buffer_store_dwordx4 v[28:31], v1, s[8:11], s12 offen offset:1024
ls_50:
  s_waitcnt vmcnt(0) lgkmcnt(0)
  s_barrier
  s_cmp_lg_u32 s4, 0
  s_cbranch_scc1 sig_51
  s_add_u32 s48, s62, 1
  v_mov_b32 v244, s48
  v_mov_b32 v246, 0
  s_mov_b64 exec, 1
  s_add_u32 s48, s46, 32768
  s_cmp_lg_u32 s44, 0
  s_cbranch_scc1 ls_52
  buffer_store_dword v244, v246, s[8:11], s48 offen sc1
  s_branch ls_53
ls_52:
  buffer_store_dword v244, v246, s[8:11], s48 offen
ls_53:
  s_mov_b64 exec, -1
  s_nop 1
sig_51:
  s_add_u32 s62, s62, 1
  s_mov_b32 s63, 1
  s_mov_b32 s47, 0
  s_mov_b32 s90, 4194304
  s_branch layer_loop
op_final:
  v_mul_u32_u24 v238, 896, v2
  v_lshl_add_u32 v238, v3, 4, v238
  s_mul_i32 s19, s95, 28672
  s_sub_u32 s49, s84, s19
  s_lshr_b32 s49, s49, 5
  s_add_u32 s19, s19, s49
  v_permlane32_swap_b32 v224, v226
  v_permlane32_swap_b32 v225, v227
  buffer_store_dwordx4 v[224:227], v238, s[32:35], s19 offen offset:0
  v_permlane32_swap_b32 v228, v230
  v_permlane32_swap_b32 v229, v231
  buffer_store_dwordx4 v[228:231], v238, s[32:35], s19 offen offset:32
k_fin:
k_end:
  s_endpgm
attn_slow:
  s_waitcnt vmcnt(0) lgkmcnt(0)
  s_nop 15
  s_mov_b32 exec_lo, 0
  v_mov_b32 v22, 0
  v_mov_b32 v23, 0
  s_mov_b32 exec_lo, -1
  v_mov_b32 v114, 0xff61b1e6
  s_mov_b32 s13, s12
  s_mov_b32 s17, 64
  s_nop 4
attn_slow1:
  buffer_load_dwordx4 v[128:131], v1, s[8:11], s13 offen sc1
  buffer_load_dwordx4 v[132:135], v1, s[8:11], s13 offen offset:1024 sc1
  s_waitcnt vmcnt(1)
  v_mfma_f32_32x32x16_bf16 v[176:191], v[128:131], v[16:19], 0
  s_waitcnt vmcnt(0)
  v_mfma_f32_32x32x16_bf16 v[176:191], v[132:135], v[20:23], v[176:191]
  s_nop 11
  v_max3_f32 v114, v176, v177, v114
  v_max3_f32 v114, v178, v179, v114
  v_max3_f32 v114, v180, v181, v114
  v_max3_f32 v114, v182, v183, v114
  v_max3_f32 v114, v184, v185, v114
  v_max3_f32 v114, v186, v187, v114
  v_max3_f32 v114, v188, v189, v114
  v_max3_f32 v114, v190, v191, v114
  s_add_u32 s13, s13, 4096
  s_nop 4
  s_sub_u32 s17, s17, 1
  s_cmp_lg_u32 s17, 0
  s_cbranch_scc1 attn_slow1
  v_mov_b32 v115, v114
  s_nop 1
  v_permlane32_swap_b32 v114, v115
  v_max_f32 v114, v114, v115
  v_mov_b32 v48, 0
  v_mov_b32 v49, 0
  v_mov_b32 v50, 0
  v_mov_b32 v51, 0
  v_mov_b32 v52, 0
  v_mov_b32 v53, 0
  v_mov_b32 v54, 0
  v_mov_b32 v55, 0
  v_mov_b32 v56, 0
  v_mov_b32 v57, 0
  v_mov_b32 v58, 0
  v_mov_b32 v59, 0
  v_mov_b32 v60, 0
  v_mov_b32 v61, 0
  v_mov_b32 v62, 0
  v_mov_b32 v63, 0
  s_mov_b32 s13, s12
  s_mov_b32 s17, 64
  s_nop 15
attn_slow2:
  buffer_load_dwordx4 v[128:131], v1, s[8:11], s13 offen sc1
  buffer_load_dwordx4 v[132:135], v1, s[8:11], s13 offen offset:1024 sc1
  buffer_load_dwordx4 v[136:139], v1, s[8:11], s13 offen offset:2048 sc1
  buffer_load_dwordx4 v[140:143], v1, s[8:11], s13 offen offset:3072 sc1
  s_waitcnt vmcnt(3)
  v_mfma_f32_32x32x16_bf16 v[176:191], v[128:131], v[16:19], 0
  s_waitcnt vmcnt(2)
  v_mfma_f32_32x32x16_bf16 v[176:191], v[132:135], v[20:23], v[176:191]
  s_nop 11
  v_sub_f32 v176, v176, v114
  v_sub_f32 v177, v177, v114
  v_sub_f32 v178, v178, v114
  v_sub_f32 v179, v179, v114
  v_sub_f32 v180, v180, v114
  v_sub_f32 v181, v181, v114
  v_sub_f32 v182, v182, v114
  v_sub_f32 v183, v183, v114
  v_sub_f32 v184, v184, v114
  v_sub_f32 v185, v185, v114
  v_sub_f32 v186, v186, v114
  v_sub_f32 v187, v187, v114
  v_sub_f32 v188, v188, v114
  v_sub_f32 v189, v189, v114
  v_sub_f32 v190, v190, v114
  v_sub_f32 v191, v191, v114
  v_exp_f32 v176, v176
  v_exp_f32 v177, v177
  v_exp_f32 v178, v178
  v_exp_f32 v179, v179
  v_exp_f32 v180, v180
  v_exp_f32 v181, v181
  v_exp_f32 v182, v182
  v_exp_f32 v183, v183
  v_exp_f32 v184, v184
  v_exp_f32 v185, v185
  v_exp_f32 v186, v186
  v_exp_f32 v187, v187
  v_exp_f32 v188, v188
  v_exp_f32 v189, v189
  v_exp_f32 v190, v190
  v_exp_f32 v191, v191
  s_waitcnt vmcnt(1)
  v_smfmac_f32_32x32x32_bf16 v[48:63], v[136:139], v[176:183], v248
  s_waitcnt vmcnt(0)
  v_smfmac_f32_32x32x32_bf16 v[48:63], v[140:143], v[184:191], v248
  s_add_u32 s13, s13, 4096
  s_nop 15
  s_sub_u32 s17, s17, 1
  s_cmp_lg_u32 s17, 0
  s_cbranch_scc1 attn_slow2
  v_mov_b32 v112, v60
  v_mov_b32 v113, v60
  s_nop 1
  v_permlane32_swap_b32 v113, v112
  s_nop 4
  s_branch attn_fin
code_end:

.section .rodata,"a"
.p2align 6
.amdhsa_kernel interleave_layers__linear_attn_block__softmax_full_mha__prompt_kernel
  .amdhsa_next_free_vgpr 512
  .amdhsa_next_free_sgpr 102
  .amdhsa_accum_offset 256
  .amdhsa_group_segment_fixed_size 0
  .amdhsa_kernarg_size 72
  .amdhsa_user_sgpr_count 2
  .amdhsa_user_sgpr_kernarg_segment_ptr 1
  .amdhsa_system_sgpr_workgroup_id_x 1
.end_amdhsa_kernel
```
